```python
import torch

def _softmax(x, axis=-1):
    return torch.softmax(x, dim=axis)
def _gelu(x):
    return torch.nn.functional.gelu(x, approximate="tanh")
def _silu(x):
    return torch.nn.functional.silu(x)
def _sigmoid(x):
    return torch.sigmoid(x)
def _layernorm(x, axis=-1, eps=1e-5):
    m = x.mean(dim=axis, keepdim=True)
    v = x.var(dim=axis, keepdim=True, unbiased=False)
    return (x - m) / torch.sqrt(v + eps)
def _scatter_add(tgt, idx, src, axis=0):
    return tgt.clone().index_add_(axis, idx, src)
def _segment_sum(src, seg, n):
    out = torch.zeros((n,) + src.shape[1:], dtype=src.dtype)
    return out.index_add_(0, seg, src)
def _pad(x, pw):
    flat = tuple(v for pair in reversed(pw) for v in pair)
    return torch.nn.functional.pad(x, flat)

kernel_name = 'interleave_layers__sliding_block__dense_activation_squared_relu__prompt'

def setup_inputs():

    _w = (lambda a: (lambda t: t.to(torch.bfloat16) if t.is_floating_point() else t)(torch.as_tensor(a)))
    def _A_setup():
        B, S, D = 1, 2048, 512
        return {
            "x": _w((lambda *s: torch.randn(*s, dtype=torch.bfloat16) * 0.05)(B, S, D)),
            "wqkv": _w((lambda *s: torch.randn(*s, dtype=torch.bfloat16) * 0.05)(D, 3 * D)),
            "wo": _w((lambda *s: torch.randn(*s, dtype=torch.bfloat16) * 0.05)(D, D)),
        }
    _A_in = _A_setup()

    def _B_setup():
        B, S, D, F = 1, 2048, 512, 1792
        return {
            "x": _w((lambda *s: torch.randn(*s, dtype=torch.bfloat16) * 0.05)(B, S, D)),
            "w1": _w((lambda *s: torch.randn(*s, dtype=torch.bfloat16) * 0.05)(D, F)),
            "b1": _w((lambda *s: torch.randn(*s, dtype=torch.bfloat16) * 0.2)(F)),
            "w2": _w((lambda *s: torch.randn(*s, dtype=torch.bfloat16) * 0.05)(F, D)),
            "b2": _w((lambda *s: torch.randn(*s, dtype=torch.bfloat16) * 0.8)(D)),
        }
    _B_in = _B_setup()

    return {
        "A_x": _A_in["x"],
        "A_wqkv": _A_in["wqkv"],
        "A_wo": _A_in["wo"],
        "B_x": _B_in["x"],
        "B_w1": _B_in["w1"],
        "B_b1": _B_in["b1"],
        "B_w2": _B_in["w2"],
        "B_b2": _B_in["b2"],
    }

def reference(A_x, A_wqkv, A_wo, B_x, B_w1, B_b1, B_w2, B_b2):
    def _A_ref(x, wqkv, wo):
        B, S, D = x.shape
        H = 32; Dh = D // H; W = 256
        qkv = (lambda x, *d: x.permute(*d))((x @ wqkv).reshape(B, S, 3, H, Dh), 2, 0, 3, 1, 4)
        q, k, v = qkv[0], qkv[1], qkv[2]
        scores = torch.einsum("bhqd,bhkd->bhqk", q, k) * (Dh ** -0.5)
        idx = torch.arange(S)
        mask = (idx[:, None] - idx[None, :] >= 0) & (idx[:, None] - idx[None, :] < W)
        scores = torch.where(mask[None, None], scores, -1e9)
        p = _softmax(scores, axis=-1)
        o = torch.einsum("bhqk,bhkd->bhqd", p, v)
        return (lambda x, *d: x.permute(*d))(o, 0, 2, 1, 3).reshape(B, S, D) @ wo

    def _B_ref(x, w1, b1, w2, b2):
        h = torch.einsum("bsd,df->bsf", x, w1) + b1
        zero = torch.zeros_like(h)
        r = torch.where(h > zero, h, zero)
        h = r * r
        out = torch.einsum("bsf,fd->bsd", h, w2) + b2
        return out

    x = A_x
    x = x + _A_ref(_layernorm(x, axis=-1), A_wqkv, A_wo)
    x = x + _B_ref(_layernorm(x, axis=-1), B_w1, B_b1, B_w2, B_b2)
    x = x + _A_ref(_layernorm(x, axis=-1), A_wqkv, A_wo)
    x = x + _B_ref(_layernorm(x, axis=-1), B_w1, B_b1, B_w2, B_b2)
    return x
```

```asm
; @launch grid=(256,1,1) block=(512,1,1) lds=163840
.amdgcn_target "amdgcn-amd-amdhsa--gfx950"
.text
.globl interleave_layers__sliding_block__dense_activation_squared_relu__prompt_kernel
.p2align 8
.type interleave_layers__sliding_block__dense_activation_squared_relu__prompt_kernel,@function
interleave_layers__sliding_block__dense_activation_squared_relu__prompt_kernel:
  s_cmp_ge_u32 s2, 256
  s_cbranch_scc1 L_end
  s_load_dwordx16 s[64:79], s[0:1], 0
  s_load_dwordx4 s[80:83], s[0:1], 64
  s_load_dwordx2 s[84:85], s[0:1], 80
  v_lshrrev_b32 v2, 6, v0
  v_and_b32 v0, 63, v0
  v_readfirstlane_b32 s46, v2
  v_lshlrev_b32 v1, 4, v0
  s_and_b32 s44, s2, 7
  s_lshl_b32 s44, s44, 1
  s_lshr_b32 s52, s2, 7
  s_or_b32 s44, s44, s52
  s_bfe_u32 s45, s2, 0x40003
  s_mov_b32 s48, 0
  s_mov_b32 s51, 0
  s_mov_b32 s94, 0
  s_mov_b32 s47, 0
  s_mov_b32 s95, 0
  s_mov_b32 s86, 0x0000ffff
  s_mov_b32 s87, 0x0000ffff
  s_mov_b32 s88, -1
  s_mov_b32 s89, 0
  s_getreg_b32 s92, hwreg(HW_REG_XCC_ID, 0, 4)
  s_lshl_b32 s49, s44, 12
  s_lshl_b32 s50, s45, 4
  s_add_u32 s50, s50, s49
  s_and_b32 s52, s46, 3
  s_lshl_b32 s52, s52, 2
  s_add_u32 s50, s50, s52
  s_waitcnt lgkmcnt(0)
  s_mov_b32 s28, s64
  s_and_b32 s29, s65, 0xffff
  s_mov_b32 s30, 2097152
  s_mov_b32 s31, 0x00020000
  s_mov_b32 s12, s66
  s_and_b32 s13, s67, 0xffff
  s_mov_b32 s14, 1572864
  s_mov_b32 s15, 0x00020000
  s_mov_b32 s16, s68
  s_and_b32 s17, s69, 0xffff
  s_mov_b32 s18, 524288
  s_mov_b32 s19, 0x00020000
  s_mov_b32 s20, s72
  s_and_b32 s21, s73, 0xffff
  s_mov_b32 s22, 1835008
  s_mov_b32 s23, 0x00020000
  s_mov_b32 s24, s76
  s_and_b32 s25, s77, 0xffff
  s_mov_b32 s26, 1835008
  s_mov_b32 s27, 0x00020000
  s_mov_b32 s32, s80
  s_and_b32 s33, s81, 0xffff
  s_mov_b32 s34, 2097152
  s_mov_b32 s35, 0x00020000
  s_mov_b32 s36, s82
  s_and_b32 s37, s83, 0xffff
  s_mov_b32 s38, 256
  s_mov_b32 s39, 0x00020000
  s_mov_b32 s8, s84
  s_and_b32 s9, s85, 0xffff
  s_mov_b32 s10, 268435456
  s_mov_b32 s11, 0x00020000
  s_cmp_lg_u32 s46, 7
  s_cbranch_scc1 L_nocpf_1
  s_lshr_b32 s54, s2, 3
  s_cmp_ge_u32 s54, (L_end - L_cpf0) >> 11
  s_cbranch_scc1 L_nocpf_1
  s_getpc_b64 s[52:53]
L_cpf0:
  s_lshl_b32 s54, s54, 11
  v_add_u32 v2, s54, v1
  global_load_dwordx4 v[60:63], v2, s[52:53]
  global_load_dwordx4 v[60:63], v2, s[52:53] offset:1024
L_nocpf_1:
  s_cmp_ge_u32 s46, 4
  s_cbranch_scc1 L_pro_helper
  s_cmp_lg_u32 s46, 3
  s_cbranch_scc1 L_nobias_2
  s_mov_b32 s40, s74
  s_and_b32 s41, s75, 0xffff
  s_mov_b32 s42, 3584
  s_mov_b32 s43, 0x00020000
  v_lshlrev_b32 v20, 1, v0
  s_lshl_b32 s54, s45, 8
  buffer_load_ushort v21, v20, s[40:43], s54 offen
  buffer_load_ushort v22, v20, s[40:43], s54 offen offset:128
  s_mov_b32 s40, s78
  s_and_b32 s41, s79, 0xffff
  s_mov_b32 s42, 1024
  s_mov_b32 s43, 0x00020000
  s_and_b32 s54, s45, 7
  s_lshl_b32 s54, s54, 7
  buffer_load_ushort v23, v20, s[40:43], s54 offen
L_nobias_2:
  s_lshl_b32 s56, s44, 2
  s_lshr_b32 s53, s45, 3
  s_lshl_b32 s53, s53, 1
  s_add_u32 s56, s56, s53
  s_and_b32 s53, s46, 1
  s_add_u32 s56, s56, s53
  s_lshr_b32 s55, s46, 1
  v_and_b32 v10, 31, v0
  v_lshlrev_b32 v10, 10, v10
  v_lshrrev_b32 v11, 5, v0
  v_lshl_add_u32 v14, v11, 4, v10
  v_lshl_add_u32 v10, v11, 3, v10
  s_lshl_b32 s52, s56, 15
  s_and_b32 s53, s45, 7
  s_lshl_b32 s53, s53, 7
  s_add_u32 s52, s52, s53
  s_lshl_b32 s53, s55, 6
  s_add_u32 s52, s52, s53
  buffer_load_dwordx2 v[248:249], v10, s[28:31], s52 offen offset:0
  buffer_load_dwordx2 v[250:251], v10, s[28:31], s52 offen offset:16
  buffer_load_dwordx2 v[252:253], v10, s[28:31], s52 offen offset:32
  buffer_load_dwordx2 v[254:255], v10, s[28:31], s52 offen offset:48
  s_lshl_b32 s61, s44, 2
  s_add_u32 s61, s61, s46
  s_lshl_b32 s61, s61, 15
  v_lshrrev_b32 v14, 3, v0
  v_and_b32 v15, 7, v0
  v_xor_b32 v15, v15, v14
  v_lshlrev_b32 v14, 10, v14
  v_lshl_add_u32 v14, v15, 4, v14
  s_mul_i32 s60, s46, 12288
  s_add_u32 s60, s60, 98304
  s_add_u32 s58, s61, 0
  buffer_load_dwordx4 v[64:67], v14, s[28:31], s58 offen
  s_add_u32 s58, s61, 8192
  buffer_load_dwordx4 v[68:71], v14, s[28:31], s58 offen
  s_add_u32 s58, s61, 16384
  buffer_load_dwordx4 v[72:75], v14, s[28:31], s58 offen
  s_add_u32 s58, s61, 24576
  buffer_load_dwordx4 v[76:79], v14, s[28:31], s58 offen
  s_add_u32 s58, s61, 128
  buffer_load_dwordx4 v[80:83], v14, s[28:31], s58 offen
  s_add_u32 s58, s61, 8320
  buffer_load_dwordx4 v[84:87], v14, s[28:31], s58 offen
  s_add_u32 s58, s61, 16512
  buffer_load_dwordx4 v[88:91], v14, s[28:31], s58 offen
  s_add_u32 s58, s61, 24704
  buffer_load_dwordx4 v[92:95], v14, s[28:31], s58 offen
  s_add_u32 s58, s61, 256
  buffer_load_dwordx4 v[96:99], v14, s[28:31], s58 offen
  s_add_u32 s58, s61, 8448
  buffer_load_dwordx4 v[100:103], v14, s[28:31], s58 offen
  s_add_u32 s58, s61, 16640
  buffer_load_dwordx4 v[104:107], v14, s[28:31], s58 offen
  s_add_u32 s58, s61, 24832
  buffer_load_dwordx4 v[108:111], v14, s[28:31], s58 offen
  s_add_u32 s58, s61, 384
  buffer_load_dwordx4 v[112:115], v14, s[28:31], s58 offen
  s_add_u32 s58, s61, 8576
  buffer_load_dwordx4 v[116:119], v14, s[28:31], s58 offen
  s_add_u32 s58, s61, 16768
  buffer_load_dwordx4 v[120:123], v14, s[28:31], s58 offen
  s_add_u32 s58, s61, 24960
  buffer_load_dwordx4 v[124:127], v14, s[28:31], s58 offen
  s_add_u32 s58, s61, 512
  buffer_load_dwordx4 v[128:131], v14, s[28:31], s58 offen
  s_add_u32 s58, s61, 8704
  buffer_load_dwordx4 v[132:135], v14, s[28:31], s58 offen
  s_add_u32 s58, s61, 16896
  buffer_load_dwordx4 v[136:139], v14, s[28:31], s58 offen
  s_add_u32 s58, s61, 25088
  buffer_load_dwordx4 v[140:143], v14, s[28:31], s58 offen
  s_add_u32 s58, s61, 640
  buffer_load_dwordx4 v[144:147], v14, s[28:31], s58 offen
  s_add_u32 s58, s61, 8832
  buffer_load_dwordx4 v[148:151], v14, s[28:31], s58 offen
  s_add_u32 s58, s61, 17024
  buffer_load_dwordx4 v[152:155], v14, s[28:31], s58 offen
  s_add_u32 s58, s61, 25216
  buffer_load_dwordx4 v[156:159], v14, s[28:31], s58 offen
  s_add_u32 s58, s61, 768
  buffer_load_dwordx4 v[160:163], v14, s[28:31], s58 offen
  s_add_u32 s58, s61, 8960
  buffer_load_dwordx4 v[164:167], v14, s[28:31], s58 offen
  s_add_u32 s58, s61, 17152
  buffer_load_dwordx4 v[168:171], v14, s[28:31], s58 offen
  s_add_u32 s58, s61, 25344
  buffer_load_dwordx4 v[172:175], v14, s[28:31], s58 offen
  s_add_u32 s58, s61, 896
  buffer_load_dwordx4 v[176:179], v14, s[28:31], s58 offen
  s_add_u32 s58, s61, 9088
  buffer_load_dwordx4 v[180:183], v14, s[28:31], s58 offen
  s_add_u32 s58, s61, 17280
  buffer_load_dwordx4 v[184:187], v14, s[28:31], s58 offen
  s_add_u32 s58, s61, 25472
  buffer_load_dwordx4 v[188:191], v14, s[28:31], s58 offen
  v_and_b32 v16, 31, v0
  v_lshrrev_b32 v17, 5, v0
  v_lshlrev_b32 v17, 2, v17
  v_sub_u32 v16, v16, v17
  v_mov_b32 v18, 0
  v_mov_b32 v19, 0xf149f2ca
  s_cmp_eq_u32 s46, 3
  s_cbranch_scc1 L_w3_5
  s_cmp_eq_u32 s46, 2
  s_cbranch_scc1 L_w2_4
  s_cmp_eq_u32 s46, 1
  s_cbranch_scc1 L_w1_3
  v_cmp_le_i32 vcc, 0, v16
  s_nop 1
  v_cndmask_b32 v24, v19, v18, vcc
  v_cmp_le_i32 vcc, 1, v16
  s_nop 1
  v_cndmask_b32 v25, v19, v18, vcc
  v_cmp_le_i32 vcc, 2, v16
  s_nop 1
  v_cndmask_b32 v26, v19, v18, vcc
  v_cmp_le_i32 vcc, 3, v16
  s_nop 1
  v_cndmask_b32 v27, v19, v18, vcc
  v_add_u32 v28, 151552, v1
  ds_write_b128 v28, v[24:27]
  s_nop 1
  v_cmp_le_i32 vcc, 8, v16
  s_nop 1
  v_cndmask_b32 v24, v19, v18, vcc
  v_cmp_le_i32 vcc, 9, v16
  s_nop 1
  v_cndmask_b32 v25, v19, v18, vcc
  v_cmp_le_i32 vcc, 10, v16
  s_nop 1
  v_cndmask_b32 v26, v19, v18, vcc
  v_cmp_le_i32 vcc, 11, v16
  s_nop 1
  v_cndmask_b32 v27, v19, v18, vcc
  v_add_u32 v28, 152576, v1
  ds_write_b128 v28, v[24:27]
  s_nop 1
  v_cmp_le_i32 vcc, 16, v16
  s_nop 1
  v_cndmask_b32 v24, v19, v18, vcc
  v_cmp_le_i32 vcc, 17, v16
  s_nop 1
  v_cndmask_b32 v25, v19, v18, vcc
  v_cmp_le_i32 vcc, 18, v16
  s_nop 1
  v_cndmask_b32 v26, v19, v18, vcc
  v_cmp_le_i32 vcc, 19, v16
  s_nop 1
  v_cndmask_b32 v27, v19, v18, vcc
  v_add_u32 v28, 153600, v1
  ds_write_b128 v28, v[24:27]
  s_nop 1
  v_cmp_le_i32 vcc, 24, v16
  s_nop 1
  v_cndmask_b32 v24, v19, v18, vcc
  v_cmp_le_i32 vcc, 25, v16
  s_nop 1
  v_cndmask_b32 v25, v19, v18, vcc
  v_cmp_le_i32 vcc, 26, v16
  s_nop 1
  v_cndmask_b32 v26, v19, v18, vcc
  v_cmp_le_i32 vcc, 27, v16
  s_nop 1
  v_cndmask_b32 v27, v19, v18, vcc
  v_add_u32 v28, 154624, v1
  ds_write_b128 v28, v[24:27]
  s_nop 1
  s_branch L_tabdone_6
L_w1_3:
  v_cmp_le_i32 vcc, 0, v16
  s_nop 1
  v_cndmask_b32 v24, v18, v19, vcc
  v_cmp_le_i32 vcc, 1, v16
  s_nop 1
  v_cndmask_b32 v25, v18, v19, vcc
  v_cmp_le_i32 vcc, 2, v16
  s_nop 1
  v_cndmask_b32 v26, v18, v19, vcc
  v_cmp_le_i32 vcc, 3, v16
  s_nop 1
  v_cndmask_b32 v27, v18, v19, vcc
  v_add_u32 v28, 155648, v1
  ds_write_b128 v28, v[24:27]
  s_nop 1
  v_cmp_le_i32 vcc, 8, v16
  s_nop 1
  v_cndmask_b32 v24, v18, v19, vcc
  v_cmp_le_i32 vcc, 9, v16
  s_nop 1
  v_cndmask_b32 v25, v18, v19, vcc
  v_cmp_le_i32 vcc, 10, v16
  s_nop 1
  v_cndmask_b32 v26, v18, v19, vcc
  v_cmp_le_i32 vcc, 11, v16
  s_nop 1
  v_cndmask_b32 v27, v18, v19, vcc
  v_add_u32 v28, 156672, v1
  ds_write_b128 v28, v[24:27]
  s_nop 1
  v_cmp_le_i32 vcc, 16, v16
  s_nop 1
  v_cndmask_b32 v24, v18, v19, vcc
  v_cmp_le_i32 vcc, 17, v16
  s_nop 1
  v_cndmask_b32 v25, v18, v19, vcc
  v_cmp_le_i32 vcc, 18, v16
  s_nop 1
  v_cndmask_b32 v26, v18, v19, vcc
  v_cmp_le_i32 vcc, 19, v16
  s_nop 1
  v_cndmask_b32 v27, v18, v19, vcc
  v_add_u32 v28, 157696, v1
  ds_write_b128 v28, v[24:27]
  s_nop 1
  v_cmp_le_i32 vcc, 24, v16
  s_nop 1
  v_cndmask_b32 v24, v18, v19, vcc
  v_cmp_le_i32 vcc, 25, v16
  s_nop 1
  v_cndmask_b32 v25, v18, v19, vcc
  v_cmp_le_i32 vcc, 26, v16
  s_nop 1
  v_cndmask_b32 v26, v18, v19, vcc
  v_cmp_le_i32 vcc, 27, v16
  s_nop 1
  v_cndmask_b32 v27, v18, v19, vcc
  v_add_u32 v28, 158720, v1
  ds_write_b128 v28, v[24:27]
  s_nop 1
  s_branch L_tabdone_6
L_w2_4:
  v_mov_b32 v29, 0xffff
  v_mov_b32 v30, 0xffff0000
  v_cmp_le_i32 vcc, 0, v16
  s_nop 1
  v_cndmask_b32 v31, v18, v29, vcc
  v_cmp_le_i32 vcc, 1, v16
  s_nop 1
  v_cndmask_b32 v32, v18, v30, vcc
  v_or_b32 v24, v31, v32
  v_cmp_le_i32 vcc, 2, v16
  s_nop 1
  v_cndmask_b32 v31, v18, v29, vcc
  v_cmp_le_i32 vcc, 3, v16
  s_nop 1
  v_cndmask_b32 v32, v18, v30, vcc
  v_or_b32 v25, v31, v32
  v_cmp_le_i32 vcc, 8, v16
  s_nop 1
  v_cndmask_b32 v31, v18, v29, vcc
  v_cmp_le_i32 vcc, 9, v16
  s_nop 1
  v_cndmask_b32 v32, v18, v30, vcc
  v_or_b32 v26, v31, v32
  v_cmp_le_i32 vcc, 10, v16
  s_nop 1
  v_cndmask_b32 v31, v18, v29, vcc
  v_cmp_le_i32 vcc, 11, v16
  s_nop 1
  v_cndmask_b32 v32, v18, v30, vcc
  v_or_b32 v27, v31, v32
  v_add_u32 v28, 159744, v1
  ds_write_b128 v28, v[24:27]
  s_nop 1
  v_cmp_le_i32 vcc, 16, v16
  s_nop 1
  v_cndmask_b32 v31, v18, v29, vcc
  v_cmp_le_i32 vcc, 17, v16
  s_nop 1
  v_cndmask_b32 v32, v18, v30, vcc
  v_or_b32 v24, v31, v32
  v_cmp_le_i32 vcc, 18, v16
  s_nop 1
  v_cndmask_b32 v31, v18, v29, vcc
  v_cmp_le_i32 vcc, 19, v16
  s_nop 1
  v_cndmask_b32 v32, v18, v30, vcc
  v_or_b32 v25, v31, v32
  v_cmp_le_i32 vcc, 24, v16
  s_nop 1
  v_cndmask_b32 v31, v18, v29, vcc
  v_cmp_le_i32 vcc, 25, v16
  s_nop 1
  v_cndmask_b32 v32, v18, v30, vcc
  v_or_b32 v26, v31, v32
  v_cmp_le_i32 vcc, 26, v16
  s_nop 1
  v_cndmask_b32 v31, v18, v29, vcc
  v_cmp_le_i32 vcc, 27, v16
  s_nop 1
  v_cndmask_b32 v32, v18, v30, vcc
  v_or_b32 v27, v31, v32
  v_add_u32 v28, 160768, v1
  ds_write_b128 v28, v[24:27]
  s_nop 1
  s_branch L_tabdone_6
L_w3_5:
  s_waitcnt vmcnt(36)
  v_lshlrev_b32 v21, 16, v21
  v_lshlrev_b32 v22, 16, v22
  v_lshlrev_b32 v23, 16, v23
  v_lshlrev_b32 v24, 2, v0
  v_add_u32 v24, 162816, v24
  ds_write_b32 v24, v21
  ds_write_b32 v24, v22 offset:256
  ds_write_b32 v24, v23 offset:512
L_tabdone_6:
  v_and_b32 v6, 31, v0
  v_lshrrev_b32 v7, 5, v0
  v_and_b32 v15, 7, v6
  v_xor_b32 v7, v7, v15
  v_lshlrev_b32 v6, 7, v6
  v_lshl_add_u32 v6, v7, 4, v6
  v_add_u32 v232, s60, v6
  v_xor_b32 v233, 32, v232
  v_xor_b32 v234, 64, v232
  v_xor_b32 v235, 96, v232
  v_add_u32 v236, s60, v1
  v_mov_b32 v8, 0x3f803f80
  v_mov_b32 v9, 0x3f803f80
  v_mov_b32 v10, 0x3f803f80
  v_mov_b32 v11, 0x3f803f80
  s_waitcnt vmcnt(28)
  ds_write_b128 v236, v[64:67] offset:0
  ds_write_b128 v236, v[68:71] offset:1024
  ds_write_b128 v236, v[72:75] offset:2048
  ds_write_b128 v236, v[76:79] offset:3072
  ds_read_b128 v[64:67], v232 offset:0
  ds_read_b128 v[68:71], v233 offset:0
  ds_read_b128 v[72:75], v234 offset:0
  ds_read_b128 v[76:79], v235 offset:0
  s_waitcnt vmcnt(24)
  ds_write_b128 v236, v[80:83] offset:4096
  ds_write_b128 v236, v[84:87] offset:5120
  ds_write_b128 v236, v[88:91] offset:6144
  ds_write_b128 v236, v[92:95] offset:7168
  ds_read_b128 v[80:83], v232 offset:4096
  ds_read_b128 v[84:87], v233 offset:4096
  ds_read_b128 v[88:91], v234 offset:4096
  ds_read_b128 v[92:95], v235 offset:4096
  s_waitcnt lgkmcnt(8)
  v_permlane32_swap_b32 v64, v66
  v_permlane32_swap_b32 v65, v67
  v_permlane32_swap_b32 v68, v70
  v_permlane32_swap_b32 v69, v71
  v_permlane32_swap_b32 v72, v74
  v_permlane32_swap_b32 v73, v75
  v_permlane32_swap_b32 v76, v78
  v_permlane32_swap_b32 v77, v79
  s_nop 0
  v_mfma_f32_32x32x16_bf16 v[16:31], v[64:67], v[64:67], 0
  v_mfma_f32_32x32x16_bf16 v[32:47], v[8:11], v[64:67], 0
  v_mfma_f32_32x32x16_bf16 v[16:31], v[68:71], v[68:71], v[16:31]
  v_mfma_f32_32x32x16_bf16 v[32:47], v[8:11], v[68:71], v[32:47]
  v_mfma_f32_32x32x16_bf16 v[16:31], v[72:75], v[72:75], v[16:31]
  v_mfma_f32_32x32x16_bf16 v[32:47], v[8:11], v[72:75], v[32:47]
  v_mfma_f32_32x32x16_bf16 v[16:31], v[76:79], v[76:79], v[16:31]
  v_mfma_f32_32x32x16_bf16 v[32:47], v[8:11], v[76:79], v[32:47]
  s_waitcnt vmcnt(20)
  ds_write_b128 v236, v[96:99] offset:8192
  ds_write_b128 v236, v[100:103] offset:9216
  ds_write_b128 v236, v[104:107] offset:10240
  ds_write_b128 v236, v[108:111] offset:11264
  ds_read_b128 v[96:99], v232 offset:8192
  ds_read_b128 v[100:103], v233 offset:8192
  ds_read_b128 v[104:107], v234 offset:8192
  ds_read_b128 v[108:111], v235 offset:8192
  s_waitcnt lgkmcnt(8)
  v_permlane32_swap_b32 v80, v82
  v_permlane32_swap_b32 v81, v83
  v_permlane32_swap_b32 v84, v86
  v_permlane32_swap_b32 v85, v87
  v_permlane32_swap_b32 v88, v90
  v_permlane32_swap_b32 v89, v91
  v_permlane32_swap_b32 v92, v94
  v_permlane32_swap_b32 v93, v95
  s_nop 0
  v_mfma_f32_32x32x16_bf16 v[16:31], v[80:83], v[80:83], v[16:31]
  v_mfma_f32_32x32x16_bf16 v[32:47], v[8:11], v[80:83], v[32:47]
  v_mfma_f32_32x32x16_bf16 v[16:31], v[84:87], v[84:87], v[16:31]
  v_mfma_f32_32x32x16_bf16 v[32:47], v[8:11], v[84:87], v[32:47]
  v_mfma_f32_32x32x16_bf16 v[16:31], v[88:91], v[88:91], v[16:31]
  v_mfma_f32_32x32x16_bf16 v[32:47], v[8:11], v[88:91], v[32:47]
  v_mfma_f32_32x32x16_bf16 v[16:31], v[92:95], v[92:95], v[16:31]
  v_mfma_f32_32x32x16_bf16 v[32:47], v[8:11], v[92:95], v[32:47]
  s_waitcnt vmcnt(16)
  ds_write_b128 v236, v[112:115] offset:0
  ds_write_b128 v236, v[116:119] offset:1024
  ds_write_b128 v236, v[120:123] offset:2048
  ds_write_b128 v236, v[124:127] offset:3072
  ds_read_b128 v[112:115], v232 offset:0
  ds_read_b128 v[116:119], v233 offset:0
  ds_read_b128 v[120:123], v234 offset:0
  ds_read_b128 v[124:127], v235 offset:0
  s_waitcnt lgkmcnt(8)
  v_permlane32_swap_b32 v96, v98
  v_permlane32_swap_b32 v97, v99
  v_permlane32_swap_b32 v100, v102
  v_permlane32_swap_b32 v101, v103
  v_permlane32_swap_b32 v104, v106
  v_permlane32_swap_b32 v105, v107
  v_permlane32_swap_b32 v108, v110
  v_permlane32_swap_b32 v109, v111
  s_nop 0
  v_mfma_f32_32x32x16_bf16 v[16:31], v[96:99], v[96:99], v[16:31]
  v_mfma_f32_32x32x16_bf16 v[32:47], v[8:11], v[96:99], v[32:47]
  v_mfma_f32_32x32x16_bf16 v[16:31], v[100:103], v[100:103], v[16:31]
  v_mfma_f32_32x32x16_bf16 v[32:47], v[8:11], v[100:103], v[32:47]
  v_mfma_f32_32x32x16_bf16 v[16:31], v[104:107], v[104:107], v[16:31]
  v_mfma_f32_32x32x16_bf16 v[32:47], v[8:11], v[104:107], v[32:47]
  v_mfma_f32_32x32x16_bf16 v[16:31], v[108:111], v[108:111], v[16:31]
  v_mfma_f32_32x32x16_bf16 v[32:47], v[8:11], v[108:111], v[32:47]
  s_waitcnt vmcnt(12)
  ds_write_b128 v236, v[128:131] offset:4096
  ds_write_b128 v236, v[132:135] offset:5120
  ds_write_b128 v236, v[136:139] offset:6144
  ds_write_b128 v236, v[140:143] offset:7168
  ds_read_b128 v[128:131], v232 offset:4096
  ds_read_b128 v[132:135], v233 offset:4096
  ds_read_b128 v[136:139], v234 offset:4096
  ds_read_b128 v[140:143], v235 offset:4096
  s_waitcnt lgkmcnt(8)
  v_permlane32_swap_b32 v112, v114
  v_permlane32_swap_b32 v113, v115
  v_permlane32_swap_b32 v116, v118
  v_permlane32_swap_b32 v117, v119
  v_permlane32_swap_b32 v120, v122
  v_permlane32_swap_b32 v121, v123
  v_permlane32_swap_b32 v124, v126
  v_permlane32_swap_b32 v125, v127
  s_nop 0
  v_mfma_f32_32x32x16_bf16 v[16:31], v[112:115], v[112:115], v[16:31]
  v_mfma_f32_32x32x16_bf16 v[32:47], v[8:11], v[112:115], v[32:47]
  v_mfma_f32_32x32x16_bf16 v[16:31], v[116:119], v[116:119], v[16:31]
  v_mfma_f32_32x32x16_bf16 v[32:47], v[8:11], v[116:119], v[32:47]
  v_mfma_f32_32x32x16_bf16 v[16:31], v[120:123], v[120:123], v[16:31]
  v_mfma_f32_32x32x16_bf16 v[32:47], v[8:11], v[120:123], v[32:47]
  v_mfma_f32_32x32x16_bf16 v[16:31], v[124:127], v[124:127], v[16:31]
  v_mfma_f32_32x32x16_bf16 v[32:47], v[8:11], v[124:127], v[32:47]
  s_waitcnt vmcnt(8)
  ds_write_b128 v236, v[144:147] offset:8192
  ds_write_b128 v236, v[148:151] offset:9216
  ds_write_b128 v236, v[152:155] offset:10240
  ds_write_b128 v236, v[156:159] offset:11264
  ds_read_b128 v[144:147], v232 offset:8192
  ds_read_b128 v[148:151], v233 offset:8192
  ds_read_b128 v[152:155], v234 offset:8192
  ds_read_b128 v[156:159], v235 offset:8192
  s_waitcnt lgkmcnt(8)
  v_permlane32_swap_b32 v128, v130
  v_permlane32_swap_b32 v129, v131
  v_permlane32_swap_b32 v132, v134
  v_permlane32_swap_b32 v133, v135
  v_permlane32_swap_b32 v136, v138
  v_permlane32_swap_b32 v137, v139
  v_permlane32_swap_b32 v140, v142
  v_permlane32_swap_b32 v141, v143
  s_nop 0
  v_mfma_f32_32x32x16_bf16 v[16:31], v[128:131], v[128:131], v[16:31]
  v_mfma_f32_32x32x16_bf16 v[32:47], v[8:11], v[128:131], v[32:47]
  v_mfma_f32_32x32x16_bf16 v[16:31], v[132:135], v[132:135], v[16:31]
  v_mfma_f32_32x32x16_bf16 v[32:47], v[8:11], v[132:135], v[32:47]
  v_mfma_f32_32x32x16_bf16 v[16:31], v[136:139], v[136:139], v[16:31]
  v_mfma_f32_32x32x16_bf16 v[32:47], v[8:11], v[136:139], v[32:47]
  v_mfma_f32_32x32x16_bf16 v[16:31], v[140:143], v[140:143], v[16:31]
  v_mfma_f32_32x32x16_bf16 v[32:47], v[8:11], v[140:143], v[32:47]
  s_waitcnt vmcnt(4)
  ds_write_b128 v236, v[160:163] offset:0
  ds_write_b128 v236, v[164:167] offset:1024
  ds_write_b128 v236, v[168:171] offset:2048
  ds_write_b128 v236, v[172:175] offset:3072
  ds_read_b128 v[160:163], v232 offset:0
  ds_read_b128 v[164:167], v233 offset:0
  ds_read_b128 v[168:171], v234 offset:0
  ds_read_b128 v[172:175], v235 offset:0
  s_waitcnt lgkmcnt(8)
  v_permlane32_swap_b32 v144, v146
  v_permlane32_swap_b32 v145, v147
  v_permlane32_swap_b32 v148, v150
  v_permlane32_swap_b32 v149, v151
  v_permlane32_swap_b32 v152, v154
  v_permlane32_swap_b32 v153, v155
  v_permlane32_swap_b32 v156, v158
  v_permlane32_swap_b32 v157, v159
  s_nop 0
  v_mfma_f32_32x32x16_bf16 v[16:31], v[144:147], v[144:147], v[16:31]
  v_mfma_f32_32x32x16_bf16 v[32:47], v[8:11], v[144:147], v[32:47]
  v_mfma_f32_32x32x16_bf16 v[16:31], v[148:151], v[148:151], v[16:31]
  v_mfma_f32_32x32x16_bf16 v[32:47], v[8:11], v[148:151], v[32:47]
  v_mfma_f32_32x32x16_bf16 v[16:31], v[152:155], v[152:155], v[16:31]
  v_mfma_f32_32x32x16_bf16 v[32:47], v[8:11], v[152:155], v[32:47]
  v_mfma_f32_32x32x16_bf16 v[16:31], v[156:159], v[156:159], v[16:31]
  v_mfma_f32_32x32x16_bf16 v[32:47], v[8:11], v[156:159], v[32:47]
  s_waitcnt vmcnt(0)
  ds_write_b128 v236, v[176:179] offset:4096
  ds_write_b128 v236, v[180:183] offset:5120
  ds_write_b128 v236, v[184:187] offset:6144
  ds_write_b128 v236, v[188:191] offset:7168
  ds_read_b128 v[176:179], v232 offset:4096
  ds_read_b128 v[180:183], v233 offset:4096
  ds_read_b128 v[184:187], v234 offset:4096
  ds_read_b128 v[188:191], v235 offset:4096
  s_waitcnt lgkmcnt(8)
  v_permlane32_swap_b32 v160, v162
  v_permlane32_swap_b32 v161, v163
  v_permlane32_swap_b32 v164, v166
  v_permlane32_swap_b32 v165, v167
  v_permlane32_swap_b32 v168, v170
  v_permlane32_swap_b32 v169, v171
  v_permlane32_swap_b32 v172, v174
  v_permlane32_swap_b32 v173, v175
  s_nop 0
  v_mfma_f32_32x32x16_bf16 v[16:31], v[160:163], v[160:163], v[16:31]
  v_mfma_f32_32x32x16_bf16 v[32:47], v[8:11], v[160:163], v[32:47]
  v_mfma_f32_32x32x16_bf16 v[16:31], v[164:167], v[164:167], v[16:31]
  v_mfma_f32_32x32x16_bf16 v[32:47], v[8:11], v[164:167], v[32:47]
  v_mfma_f32_32x32x16_bf16 v[16:31], v[168:171], v[168:171], v[16:31]
  v_mfma_f32_32x32x16_bf16 v[32:47], v[8:11], v[168:171], v[32:47]
  v_mfma_f32_32x32x16_bf16 v[16:31], v[172:175], v[172:175], v[16:31]
  v_mfma_f32_32x32x16_bf16 v[32:47], v[8:11], v[172:175], v[32:47]
  s_waitcnt lgkmcnt(0)
  v_permlane32_swap_b32 v176, v178
  v_permlane32_swap_b32 v177, v179
  v_permlane32_swap_b32 v180, v182
  v_permlane32_swap_b32 v181, v183
  v_permlane32_swap_b32 v184, v186
  v_permlane32_swap_b32 v185, v187
  v_permlane32_swap_b32 v188, v190
  v_permlane32_swap_b32 v189, v191
  s_nop 0
  v_mfma_f32_32x32x16_bf16 v[16:31], v[176:179], v[176:179], v[16:31]
  v_mfma_f32_32x32x16_bf16 v[32:47], v[8:11], v[176:179], v[32:47]
  v_mfma_f32_32x32x16_bf16 v[16:31], v[180:183], v[180:183], v[16:31]
  v_mfma_f32_32x32x16_bf16 v[32:47], v[8:11], v[180:183], v[32:47]
  v_mfma_f32_32x32x16_bf16 v[16:31], v[184:187], v[184:187], v[16:31]
  v_mfma_f32_32x32x16_bf16 v[32:47], v[8:11], v[184:187], v[32:47]
  v_mfma_f32_32x32x16_bf16 v[16:31], v[188:191], v[188:191], v[16:31]
  v_mfma_f32_32x32x16_bf16 v[32:47], v[8:11], v[188:191], v[32:47]
  v_and_b32 v6, 31, v0
  v_lshrrev_b32 v7, 5, v0
  v_lshlrev_b32 v7, 2, v7
  v_sub_u32 v6, v6, v7
  v_mov_b32 v217, 0
  s_nop 7
  v_cmp_eq_u32 vcc, 0, v6
  s_nop 1
  v_cndmask_b32 v217, v217, v16, vcc
  v_cmp_eq_u32 vcc, 1, v6
  s_nop 1
  v_cndmask_b32 v217, v217, v17, vcc
  v_cmp_eq_u32 vcc, 2, v6
  s_nop 1
  v_cndmask_b32 v217, v217, v18, vcc
  v_cmp_eq_u32 vcc, 3, v6
  s_nop 1
  v_cndmask_b32 v217, v217, v19, vcc
  v_cmp_eq_u32 vcc, 8, v6
  s_nop 1
  v_cndmask_b32 v217, v217, v20, vcc
  v_cmp_eq_u32 vcc, 9, v6
  s_nop 1
  v_cndmask_b32 v217, v217, v21, vcc
  v_cmp_eq_u32 vcc, 10, v6
  s_nop 1
  v_cndmask_b32 v217, v217, v22, vcc
  v_cmp_eq_u32 vcc, 11, v6
  s_nop 1
  v_cndmask_b32 v217, v217, v23, vcc
  v_cmp_eq_u32 vcc, 16, v6
  s_nop 1
  v_cndmask_b32 v217, v217, v24, vcc
  v_cmp_eq_u32 vcc, 17, v6
  s_nop 1
  v_cndmask_b32 v217, v217, v25, vcc
  v_cmp_eq_u32 vcc, 18, v6
  s_nop 1
  v_cndmask_b32 v217, v217, v26, vcc
  v_cmp_eq_u32 vcc, 19, v6
  s_nop 1
  v_cndmask_b32 v217, v217, v27, vcc
  v_cmp_eq_u32 vcc, 24, v6
  s_nop 1
  v_cndmask_b32 v217, v217, v28, vcc
  v_cmp_eq_u32 vcc, 25, v6
  s_nop 1
  v_cndmask_b32 v217, v217, v29, vcc
  v_cmp_eq_u32 vcc, 26, v6
  s_nop 1
  v_cndmask_b32 v217, v217, v30, vcc
  v_cmp_eq_u32 vcc, 27, v6
  s_nop 1
  v_cndmask_b32 v217, v217, v31, vcc
  v_mul_f32 v216, 0.5, v32
  v_lshrrev_b32 v4, 5, v0
  v_lshlrev_b32 v4, 2, v4
  v_bfe_u32 v6, v0, 2, 2
  v_add_u32 v4, v4, v6
  v_bfe_u32 v5, v0, 4, 1
  v_lshlrev_b32 v5, 5, v5
  v_and_b32 v6, 3, v0
  v_lshlrev_b32 v6, 3, v6
  v_add_u32 v5, v5, v6
  v_lshl_add_u32 v4, v4, 6, v5
  v_add_u32 v5, 65536, v4
  s_barrier
  ds_read_b64_tr_b16 v[192:193], v4 offset:32768
  ds_read_b64_tr_b16 v[194:195], v4 offset:33280
  ds_read_b64_tr_b16 v[196:197], v5 offset:0
  ds_read_b64_tr_b16 v[198:199], v5 offset:512
  ds_read_b64_tr_b16 v[200:201], v4 offset:33792
  ds_read_b64_tr_b16 v[202:203], v4 offset:34304
  ds_read_b64_tr_b16 v[204:205], v5 offset:1024
  ds_read_b64_tr_b16 v[206:207], v5 offset:1536
  ds_read_b64_tr_b16 v[208:209], v4 offset:34816
  ds_read_b64_tr_b16 v[210:211], v4 offset:35328
  s_waitcnt lgkmcnt(8)
  v_mfma_f32_32x32x16_bf16 v[32:47], v[192:195], v[64:67], 0
  ds_read_b64_tr_b16 v[212:213], v5 offset:2048
  ds_read_b64_tr_b16 v[214:215], v5 offset:2560
  s_waitcnt lgkmcnt(8)
  v_mfma_f32_32x32x16_bf16 v[48:63], v[64:67], v[196:199], 0
  ds_read_b64_tr_b16 v[192:193], v4 offset:35840
  ds_read_b64_tr_b16 v[194:195], v4 offset:36352
  s_waitcnt lgkmcnt(8)
  v_mfma_f32_32x32x16_bf16 v[32:47], v[200:203], v[68:71], v[32:47]
  ds_read_b64_tr_b16 v[196:197], v5 offset:3072
  ds_read_b64_tr_b16 v[198:199], v5 offset:3584
  s_waitcnt lgkmcnt(8)
  v_mfma_f32_32x32x16_bf16 v[48:63], v[68:71], v[204:207], v[48:63]
  ds_read_b64_tr_b16 v[200:201], v4 offset:36864
  ds_read_b64_tr_b16 v[202:203], v4 offset:37376
  s_waitcnt lgkmcnt(8)
  v_mfma_f32_32x32x16_bf16 v[32:47], v[208:211], v[72:75], v[32:47]
  ds_read_b64_tr_b16 v[204:205], v5 offset:4096
  ds_read_b64_tr_b16 v[206:207], v5 offset:4608
  s_waitcnt lgkmcnt(8)
  v_mfma_f32_32x32x16_bf16 v[48:63], v[72:75], v[212:215], v[48:63]
  ds_read_b64_tr_b16 v[208:209], v4 offset:37888
  ds_read_b64_tr_b16 v[210:211], v4 offset:38400
  s_waitcnt lgkmcnt(8)
  v_mfma_f32_32x32x16_bf16 v[32:47], v[192:195], v[76:79], v[32:47]
  ds_read_b64_tr_b16 v[212:213], v5 offset:5120
  ds_read_b64_tr_b16 v[214:215], v5 offset:5632
  s_waitcnt lgkmcnt(8)
  v_mfma_f32_32x32x16_bf16 v[48:63], v[76:79], v[196:199], v[48:63]
  ds_read_b64_tr_b16 v[192:193], v4 offset:38912
  ds_read_b64_tr_b16 v[194:195], v4 offset:39424
  s_waitcnt lgkmcnt(8)
  v_mfma_f32_32x32x16_bf16 v[32:47], v[200:203], v[80:83], v[32:47]
  ds_read_b64_tr_b16 v[196:197], v5 offset:6144
  ds_read_b64_tr_b16 v[198:199], v5 offset:6656
  s_waitcnt lgkmcnt(8)
  v_mfma_f32_32x32x16_bf16 v[48:63], v[80:83], v[204:207], v[48:63]
  ds_read_b64_tr_b16 v[200:201], v4 offset:39936
  ds_read_b64_tr_b16 v[202:203], v4 offset:40448
  s_waitcnt lgkmcnt(8)
  v_mfma_f32_32x32x16_bf16 v[32:47], v[208:211], v[84:87], v[32:47]
  ds_read_b64_tr_b16 v[204:205], v5 offset:7168
  ds_read_b64_tr_b16 v[206:207], v5 offset:7680
  s_waitcnt lgkmcnt(8)
  v_mfma_f32_32x32x16_bf16 v[48:63], v[84:87], v[212:215], v[48:63]
  s_barrier
  ds_read_b64_tr_b16 v[208:209], v4 offset:40960
  ds_read_b64_tr_b16 v[210:211], v4 offset:41472
  s_waitcnt lgkmcnt(8)
  v_mfma_f32_32x32x16_bf16 v[32:47], v[192:195], v[88:91], v[32:47]
  ds_read_b64_tr_b16 v[212:213], v5 offset:8192
  ds_read_b64_tr_b16 v[214:215], v5 offset:8704
  s_waitcnt lgkmcnt(8)
  v_mfma_f32_32x32x16_bf16 v[48:63], v[88:91], v[196:199], v[48:63]
  ds_read_b64_tr_b16 v[192:193], v4 offset:41984
  ds_read_b64_tr_b16 v[194:195], v4 offset:42496
  s_waitcnt lgkmcnt(8)
  v_mfma_f32_32x32x16_bf16 v[32:47], v[200:203], v[92:95], v[32:47]
  ds_read_b64_tr_b16 v[196:197], v5 offset:9216
  ds_read_b64_tr_b16 v[198:199], v5 offset:9728
  s_waitcnt lgkmcnt(8)
  v_mfma_f32_32x32x16_bf16 v[48:63], v[92:95], v[204:207], v[48:63]
  ds_read_b64_tr_b16 v[200:201], v4 offset:43008
  ds_read_b64_tr_b16 v[202:203], v4 offset:43520
  s_waitcnt lgkmcnt(8)
  v_mfma_f32_32x32x16_bf16 v[32:47], v[208:211], v[96:99], v[32:47]
  ds_read_b64_tr_b16 v[204:205], v5 offset:10240
  ds_read_b64_tr_b16 v[206:207], v5 offset:10752
  v_mov_b32 v218, v216
  v_mov_b32 v219, v217
  s_nop 1
  v_permlane32_swap_b32 v218, v216
  v_permlane32_swap_b32 v219, v217
  s_nop 0
  v_pk_add_f32 v[216:217], v[216:217], v[218:219]
  v_mul_f32 v216, 0x3b000000, v216
  v_mul_f32 v217, 0x3b000000, v217
  v_fma_f32 v217, -v216, v216, v217
  v_max_f32 v217, 0, v217
  v_add_f32 v217, 0x3727c5ac, v217
  v_rsq_f32 v8, v217
  s_nop 0
  v_mul_f32 v10, v216, v8
  v_and_b32 v6, 31, v0
  v_lshlrev_b32 v6, 2, v6
  v_add_u32 v13, 162048, v6
  s_lshl_b32 s52, s46, 8
  s_add_u32 s52, s52, 147456
  v_add_u32 v6, s52, v6
  ds_write_b32 v6, v8
  ds_write_b32 v6, v10 offset:128
  v_lshrrev_b32 v7, 5, v0
  v_lshlrev_b32 v7, 4, v7
  v_add_u32 v6, 161792, v7
  v_add_u32 v7, s52, v7
  s_waitcnt lgkmcnt(10)
  v_mfma_f32_32x32x16_bf16 v[48:63], v[96:99], v[212:215], v[48:63]
  ds_read_b64_tr_b16 v[208:209], v4 offset:44032
  ds_read_b64_tr_b16 v[210:211], v4 offset:44544
  s_waitcnt lgkmcnt(10)
  v_mfma_f32_32x32x16_bf16 v[32:47], v[192:195], v[100:103], v[32:47]
  ds_read_b64_tr_b16 v[212:213], v5 offset:11264
  ds_read_b64_tr_b16 v[214:215], v5 offset:11776
  s_waitcnt lgkmcnt(10)
  v_mfma_f32_32x32x16_bf16 v[48:63], v[100:103], v[196:199], v[48:63]
  ds_read_b64_tr_b16 v[192:193], v4 offset:45056
  ds_read_b64_tr_b16 v[194:195], v4 offset:45568
  s_waitcnt lgkmcnt(10)
  v_mfma_f32_32x32x16_bf16 v[32:47], v[200:203], v[104:107], v[32:47]
  ds_read_b64_tr_b16 v[196:197], v5 offset:12288
  ds_read_b64_tr_b16 v[198:199], v5 offset:12800
  s_waitcnt lgkmcnt(10)
  v_mfma_f32_32x32x16_bf16 v[48:63], v[104:107], v[204:207], v[48:63]
  ds_read_b64_tr_b16 v[200:201], v4 offset:46080
  ds_read_b64_tr_b16 v[202:203], v4 offset:46592
  s_waitcnt lgkmcnt(8)
  v_mfma_f32_32x32x16_bf16 v[32:47], v[208:211], v[108:111], v[32:47]
  ds_read_b64_tr_b16 v[204:205], v5 offset:13312
  ds_read_b64_tr_b16 v[206:207], v5 offset:13824
  s_waitcnt lgkmcnt(8)
  v_mfma_f32_32x32x16_bf16 v[48:63], v[108:111], v[212:215], v[48:63]
  ds_read_b64_tr_b16 v[208:209], v4 offset:47104
  ds_read_b64_tr_b16 v[210:211], v4 offset:47616
  s_waitcnt lgkmcnt(8)
  v_mfma_f32_32x32x16_bf16 v[32:47], v[192:195], v[112:115], v[32:47]
  ds_read_b64_tr_b16 v[212:213], v5 offset:14336
  ds_read_b64_tr_b16 v[214:215], v5 offset:14848
  s_waitcnt lgkmcnt(8)
  v_mfma_f32_32x32x16_bf16 v[48:63], v[112:115], v[196:199], v[48:63]
  ds_read_b64_tr_b16 v[192:193], v4 offset:48128
  ds_read_b64_tr_b16 v[194:195], v4 offset:48640
  s_waitcnt lgkmcnt(8)
  v_mfma_f32_32x32x16_bf16 v[32:47], v[200:203], v[116:119], v[32:47]
  ds_read_b64_tr_b16 v[196:197], v5 offset:15360
  ds_read_b64_tr_b16 v[198:199], v5 offset:15872
  s_waitcnt lgkmcnt(8)
  v_mfma_f32_32x32x16_bf16 v[48:63], v[116:119], v[204:207], v[48:63]
  s_barrier
  ds_read_b64_tr_b16 v[200:201], v4 offset:49152
  ds_read_b64_tr_b16 v[202:203], v4 offset:49664
  s_waitcnt lgkmcnt(8)
  v_mfma_f32_32x32x16_bf16 v[32:47], v[208:211], v[120:123], v[32:47]
  ds_read_b64_tr_b16 v[204:205], v5 offset:16384
  ds_read_b64_tr_b16 v[206:207], v5 offset:16896
  s_waitcnt lgkmcnt(8)
  v_mfma_f32_32x32x16_bf16 v[48:63], v[120:123], v[212:215], v[48:63]
  ds_read_b64_tr_b16 v[208:209], v4 offset:50176
  ds_read_b64_tr_b16 v[210:211], v4 offset:50688
  s_waitcnt lgkmcnt(8)
  v_mfma_f32_32x32x16_bf16 v[32:47], v[192:195], v[124:127], v[32:47]
  ds_read_b64_tr_b16 v[212:213], v5 offset:17408
  ds_read_b64_tr_b16 v[214:215], v5 offset:17920
  s_waitcnt lgkmcnt(8)
  v_mfma_f32_32x32x16_bf16 v[48:63], v[124:127], v[196:199], v[48:63]
  ds_read_b64_tr_b16 v[192:193], v4 offset:51200
  ds_read_b64_tr_b16 v[194:195], v4 offset:51712
  s_waitcnt lgkmcnt(8)
  v_mfma_f32_32x32x16_bf16 v[32:47], v[200:203], v[128:131], v[32:47]
  ds_read_b64_tr_b16 v[196:197], v5 offset:18432
  ds_read_b64_tr_b16 v[198:199], v5 offset:18944
  s_waitcnt lgkmcnt(8)
  v_mfma_f32_32x32x16_bf16 v[48:63], v[128:131], v[204:207], v[48:63]
  ds_read_b64_tr_b16 v[200:201], v4 offset:52224
  ds_read_b64_tr_b16 v[202:203], v4 offset:52736
  s_waitcnt lgkmcnt(8)
  v_mfma_f32_32x32x16_bf16 v[32:47], v[208:211], v[132:135], v[32:47]
  ds_read_b64_tr_b16 v[204:205], v5 offset:19456
  ds_read_b64_tr_b16 v[206:207], v5 offset:19968
  s_waitcnt lgkmcnt(8)
  v_mfma_f32_32x32x16_bf16 v[48:63], v[132:135], v[212:215], v[48:63]
  ds_read_b64_tr_b16 v[208:209], v4 offset:53248
  ds_read_b64_tr_b16 v[210:211], v4 offset:53760
  s_waitcnt lgkmcnt(8)
  v_mfma_f32_32x32x16_bf16 v[32:47], v[192:195], v[136:139], v[32:47]
  ds_read_b64_tr_b16 v[212:213], v5 offset:20480
  ds_read_b64_tr_b16 v[214:215], v5 offset:20992
  s_waitcnt lgkmcnt(8)
  v_mfma_f32_32x32x16_bf16 v[48:63], v[136:139], v[196:199], v[48:63]
  ds_read_b64_tr_b16 v[192:193], v4 offset:54272
  ds_read_b64_tr_b16 v[194:195], v4 offset:54784
  s_waitcnt lgkmcnt(8)
  v_mfma_f32_32x32x16_bf16 v[32:47], v[200:203], v[140:143], v[32:47]
  ds_read_b64_tr_b16 v[196:197], v5 offset:21504
  ds_read_b64_tr_b16 v[198:199], v5 offset:22016
  s_waitcnt lgkmcnt(8)
  v_mfma_f32_32x32x16_bf16 v[48:63], v[140:143], v[204:207], v[48:63]
  ds_read_b64_tr_b16 v[200:201], v4 offset:55296
  ds_read_b64_tr_b16 v[202:203], v4 offset:55808
  s_waitcnt lgkmcnt(8)
  v_mfma_f32_32x32x16_bf16 v[32:47], v[208:211], v[144:147], v[32:47]
  ds_read_b64_tr_b16 v[204:205], v5 offset:22528
  ds_read_b64_tr_b16 v[206:207], v5 offset:23040
  s_waitcnt lgkmcnt(8)
  v_mfma_f32_32x32x16_bf16 v[48:63], v[144:147], v[212:215], v[48:63]
  ds_read_b64_tr_b16 v[208:209], v4 offset:56320
  ds_read_b64_tr_b16 v[210:211], v4 offset:56832
  s_waitcnt lgkmcnt(8)
  v_mfma_f32_32x32x16_bf16 v[32:47], v[192:195], v[148:151], v[32:47]
  ds_read_b64_tr_b16 v[212:213], v5 offset:23552
  ds_read_b64_tr_b16 v[214:215], v5 offset:24064
  s_waitcnt lgkmcnt(8)
  v_mfma_f32_32x32x16_bf16 v[48:63], v[148:151], v[196:199], v[48:63]
  s_barrier
  ds_read_b64_tr_b16 v[192:193], v4 offset:57344
  ds_read_b64_tr_b16 v[194:195], v4 offset:57856
  s_waitcnt lgkmcnt(8)
  v_mfma_f32_32x32x16_bf16 v[32:47], v[200:203], v[152:155], v[32:47]
  ds_read_b64_tr_b16 v[196:197], v5 offset:24576
  ds_read_b64_tr_b16 v[198:199], v5 offset:25088
  s_waitcnt lgkmcnt(8)
  v_mfma_f32_32x32x16_bf16 v[48:63], v[152:155], v[204:207], v[48:63]
  ds_read_b64_tr_b16 v[200:201], v4 offset:58368
  ds_read_b64_tr_b16 v[202:203], v4 offset:58880
  s_waitcnt lgkmcnt(8)
  v_mfma_f32_32x32x16_bf16 v[32:47], v[208:211], v[156:159], v[32:47]
  ds_read_b64_tr_b16 v[204:205], v5 offset:25600
  ds_read_b64_tr_b16 v[206:207], v5 offset:26112
  s_waitcnt lgkmcnt(8)
  v_mfma_f32_32x32x16_bf16 v[48:63], v[156:159], v[212:215], v[48:63]
  ds_read_b64_tr_b16 v[208:209], v4 offset:59392
  ds_read_b64_tr_b16 v[210:211], v4 offset:59904
  s_waitcnt lgkmcnt(8)
  v_mfma_f32_32x32x16_bf16 v[32:47], v[192:195], v[160:163], v[32:47]
  ds_read_b64_tr_b16 v[212:213], v5 offset:26624
  ds_read_b64_tr_b16 v[214:215], v5 offset:27136
  s_waitcnt lgkmcnt(8)
  v_mfma_f32_32x32x16_bf16 v[48:63], v[160:163], v[196:199], v[48:63]
  ds_read_b64_tr_b16 v[192:193], v4 offset:60416
  ds_read_b64_tr_b16 v[194:195], v4 offset:60928
  s_waitcnt lgkmcnt(8)
  v_mfma_f32_32x32x16_bf16 v[32:47], v[200:203], v[164:167], v[32:47]
  ds_read_b64_tr_b16 v[196:197], v5 offset:27648
  ds_read_b64_tr_b16 v[198:199], v5 offset:28160
  s_waitcnt lgkmcnt(8)
  v_mfma_f32_32x32x16_bf16 v[48:63], v[164:167], v[204:207], v[48:63]
  ds_read_b64_tr_b16 v[200:201], v4 offset:61440
  ds_read_b64_tr_b16 v[202:203], v4 offset:61952
  s_waitcnt lgkmcnt(8)
  v_mfma_f32_32x32x16_bf16 v[32:47], v[208:211], v[168:171], v[32:47]
  ds_read_b64_tr_b16 v[204:205], v5 offset:28672
  ds_read_b64_tr_b16 v[206:207], v5 offset:29184
  s_waitcnt lgkmcnt(8)
  v_mfma_f32_32x32x16_bf16 v[48:63], v[168:171], v[212:215], v[48:63]
  ds_read_b64_tr_b16 v[208:209], v4 offset:62464
  ds_read_b64_tr_b16 v[210:211], v4 offset:62976
  s_waitcnt lgkmcnt(8)
  v_mfma_f32_32x32x16_bf16 v[32:47], v[192:195], v[172:175], v[32:47]
  ds_read_b64_tr_b16 v[212:213], v5 offset:29696
  ds_read_b64_tr_b16 v[214:215], v5 offset:30208
  s_waitcnt lgkmcnt(8)
  v_mfma_f32_32x32x16_bf16 v[48:63], v[172:175], v[196:199], v[48:63]
  ds_read_b64_tr_b16 v[192:193], v4 offset:63488
  ds_read_b64_tr_b16 v[194:195], v4 offset:64000
  s_waitcnt lgkmcnt(8)
  v_mfma_f32_32x32x16_bf16 v[32:47], v[200:203], v[176:179], v[32:47]
  ds_read_b64_tr_b16 v[196:197], v5 offset:30720
  ds_read_b64_tr_b16 v[198:199], v5 offset:31232
  s_waitcnt lgkmcnt(8)
  v_mfma_f32_32x32x16_bf16 v[48:63], v[176:179], v[204:207], v[48:63]
  ds_read_b64_tr_b16 v[200:201], v4 offset:64512
  ds_read_b64_tr_b16 v[202:203], v4 offset:65024
  s_waitcnt lgkmcnt(8)
  v_mfma_f32_32x32x16_bf16 v[32:47], v[208:211], v[180:183], v[32:47]
  ds_read_b64_tr_b16 v[204:205], v5 offset:31744
  ds_read_b64_tr_b16 v[206:207], v5 offset:32256
  s_waitcnt lgkmcnt(8)
  v_mfma_f32_32x32x16_bf16 v[48:63], v[180:183], v[212:215], v[48:63]
  ds_read_b64_tr_b16 v[208:209], v4 offset:0
  ds_read_b64_tr_b16 v[210:211], v4 offset:512
  s_waitcnt lgkmcnt(8)
  v_mfma_f32_32x32x16_bf16 v[32:47], v[192:195], v[184:187], v[32:47]
  ds_read_b64_tr_b16 v[212:213], v4 offset:1024
  ds_read_b64_tr_b16 v[214:215], v4 offset:1536
  s_waitcnt lgkmcnt(8)
  v_mfma_f32_32x32x16_bf16 v[48:63], v[184:187], v[196:199], v[48:63]
  ds_read_b64_tr_b16 v[192:193], v4 offset:2048
  ds_read_b64_tr_b16 v[194:195], v4 offset:2560
  s_waitcnt lgkmcnt(8)
  v_mfma_f32_32x32x16_bf16 v[32:47], v[200:203], v[188:191], v[32:47]
  ds_read_b64_tr_b16 v[196:197], v4 offset:3072
  ds_read_b64_tr_b16 v[198:199], v4 offset:3584
  s_waitcnt lgkmcnt(8)
  v_mfma_f32_32x32x16_bf16 v[48:63], v[188:191], v[204:207], v[48:63]
  ds_read_b64_tr_b16 v[200:201], v4 offset:4096
  ds_read_b64_tr_b16 v[202:203], v4 offset:4608
  s_barrier
  s_branch L_p1_passB
L_p1_l1:
  s_lshl_b32 s90, s48, 2
  s_add_u32 s90, s90, 0
  v_lshlrev_b32 v4, 2, v0
  s_mov_b32 s91, 262144
  s_cmp_eq_u32 s51, 0
  s_cbranch_scc0 L_pdone_8
L_poll_7:
  buffer_load_dword v5, v4, s[8:11], s49 offen sc1
  s_waitcnt vmcnt(0)
  v_cmp_gt_u32 vcc, s90, v5
  s_cbranch_vccz L_pdone_8
  s_sleep 1
  s_sub_u32 s91, s91, 1
  s_cbranch_scc0 L_poll_7
  s_mov_b32 s51, 1
L_pdone_8:
  s_lshl_b32 s56, s44, 2
  s_add_u32 s56, s56, s46
  s_mul_i32 s61, s56, 32768
  s_add_u32 s61, s61, 1048576
  buffer_load_dwordx4 v[64:67], v1, s[8:11], s61 offen offset:0 sc1
  buffer_load_dwordx4 v[68:71], v1, s[8:11], s61 offen offset:1024 sc1
  buffer_load_dwordx4 v[72:75], v1, s[8:11], s61 offen offset:2048 sc1
  buffer_load_dwordx4 v[76:79], v1, s[8:11], s61 offen offset:3072 sc1
  s_add_u32 s61, s61, 4096
  buffer_load_dwordx4 v[80:83], v1, s[8:11], s61 offen offset:0 sc1
  buffer_load_dwordx4 v[84:87], v1, s[8:11], s61 offen offset:1024 sc1
  buffer_load_dwordx4 v[88:91], v1, s[8:11], s61 offen offset:2048 sc1
  buffer_load_dwordx4 v[92:95], v1, s[8:11], s61 offen offset:3072 sc1
  v_lshrrev_b32 v14, 5, v0
  v_lshlrev_b32 v14, 11, v14
  v_and_b32 v15, 31, v0
  v_lshl_add_u32 v14, v15, 3, v14
  s_lshl_b32 s57, s56, 12
  s_add_u32 s57, s57, 7340032
  buffer_load_dwordx2 v[216:217], v14, s[8:11], s57 offen offset:0 sc1
  buffer_load_dwordx2 v[218:219], v14, s[8:11], s57 offen offset:256 sc1
  buffer_load_dwordx2 v[220:221], v14, s[8:11], s57 offen offset:512 sc1
  buffer_load_dwordx2 v[222:223], v14, s[8:11], s57 offen offset:768 sc1
  buffer_load_dwordx2 v[224:225], v14, s[8:11], s57 offen offset:1024 sc1
  buffer_load_dwordx2 v[226:227], v14, s[8:11], s57 offen offset:1280 sc1
  buffer_load_dwordx2 v[228:229], v14, s[8:11], s57 offen offset:1536 sc1
  buffer_load_dwordx2 v[230:231], v14, s[8:11], s57 offen offset:1792 sc1
  v_lshrrev_b32 v4, 5, v0
  v_lshlrev_b32 v4, 2, v4
  v_bfe_u32 v6, v0, 2, 2
  v_add_u32 v4, v4, v6
  v_bfe_u32 v5, v0, 4, 1
  v_lshlrev_b32 v5, 5, v5
  v_and_b32 v6, 3, v0
  v_lshlrev_b32 v6, 3, v6
  v_add_u32 v5, v5, v6
  v_lshl_add_u32 v4, v4, 6, v5
  v_add_u32 v5, 65536, v4
  s_barrier
  ds_read_b64_tr_b16 v[192:193], v4 offset:32768
  ds_read_b64_tr_b16 v[194:195], v4 offset:33280
  ds_read_b64_tr_b16 v[196:197], v5 offset:0
  ds_read_b64_tr_b16 v[198:199], v5 offset:512
  ds_read_b64_tr_b16 v[200:201], v4 offset:33792
  ds_read_b64_tr_b16 v[202:203], v4 offset:34304
  ds_read_b64_tr_b16 v[204:205], v5 offset:1024
  ds_read_b64_tr_b16 v[206:207], v5 offset:1536
  ds_read_b64_tr_b16 v[208:209], v4 offset:34816
  ds_read_b64_tr_b16 v[210:211], v4 offset:35328
  s_waitcnt vmcnt(15)
  s_add_u32 s61, s61, 4096
  buffer_load_dwordx4 v[96:99], v1, s[8:11], s61 offen offset:0 sc1
  s_waitcnt lgkmcnt(8)
  v_mfma_f32_32x32x16_bf16 v[32:47], v[192:195], v[64:67], 0
  ds_read_b64_tr_b16 v[212:213], v5 offset:2048
  ds_read_b64_tr_b16 v[214:215], v5 offset:2560
  s_waitcnt lgkmcnt(8)
  v_mfma_f32_32x32x16_bf16 v[48:63], v[64:67], v[196:199], 0
  ds_read_b64_tr_b16 v[192:193], v4 offset:35840
  ds_read_b64_tr_b16 v[194:195], v4 offset:36352
  s_waitcnt vmcnt(15)
  buffer_load_dwordx4 v[100:103], v1, s[8:11], s61 offen offset:1024 sc1
  s_waitcnt lgkmcnt(8)
  v_mfma_f32_32x32x16_bf16 v[32:47], v[200:203], v[68:71], v[32:47]
  ds_read_b64_tr_b16 v[196:197], v5 offset:3072
  ds_read_b64_tr_b16 v[198:199], v5 offset:3584
  s_waitcnt lgkmcnt(8)
  v_mfma_f32_32x32x16_bf16 v[48:63], v[68:71], v[204:207], v[48:63]
  ds_read_b64_tr_b16 v[200:201], v4 offset:36864
  ds_read_b64_tr_b16 v[202:203], v4 offset:37376
  s_waitcnt vmcnt(15)
  buffer_load_dwordx4 v[104:107], v1, s[8:11], s61 offen offset:2048 sc1
  s_waitcnt lgkmcnt(8)
  v_mfma_f32_32x32x16_bf16 v[32:47], v[208:211], v[72:75], v[32:47]
  ds_read_b64_tr_b16 v[204:205], v5 offset:4096
  ds_read_b64_tr_b16 v[206:207], v5 offset:4608
  s_waitcnt lgkmcnt(8)
  v_mfma_f32_32x32x16_bf16 v[48:63], v[72:75], v[212:215], v[48:63]
  ds_read_b64_tr_b16 v[208:209], v4 offset:37888
  ds_read_b64_tr_b16 v[210:211], v4 offset:38400
  s_waitcnt vmcnt(15)
  buffer_load_dwordx4 v[108:111], v1, s[8:11], s61 offen offset:3072 sc1
  s_waitcnt lgkmcnt(8)
  v_mfma_f32_32x32x16_bf16 v[32:47], v[192:195], v[76:79], v[32:47]
  ds_read_b64_tr_b16 v[212:213], v5 offset:5120
  ds_read_b64_tr_b16 v[214:215], v5 offset:5632
  s_waitcnt lgkmcnt(8)
  v_mfma_f32_32x32x16_bf16 v[48:63], v[76:79], v[196:199], v[48:63]
  ds_read_b64_tr_b16 v[192:193], v4 offset:38912
  ds_read_b64_tr_b16 v[194:195], v4 offset:39424
  s_waitcnt vmcnt(15)
  s_add_u32 s61, s61, 4096
  buffer_load_dwordx4 v[112:115], v1, s[8:11], s61 offen offset:0 sc1
  s_waitcnt lgkmcnt(8)
  v_mfma_f32_32x32x16_bf16 v[32:47], v[200:203], v[80:83], v[32:47]
  ds_read_b64_tr_b16 v[196:197], v5 offset:6144
  ds_read_b64_tr_b16 v[198:199], v5 offset:6656
  s_waitcnt lgkmcnt(8)
  v_mfma_f32_32x32x16_bf16 v[48:63], v[80:83], v[204:207], v[48:63]
  ds_read_b64_tr_b16 v[200:201], v4 offset:39936
  ds_read_b64_tr_b16 v[202:203], v4 offset:40448
  s_waitcnt vmcnt(15)
  buffer_load_dwordx4 v[116:119], v1, s[8:11], s61 offen offset:1024 sc1
  s_waitcnt lgkmcnt(8)
  v_mfma_f32_32x32x16_bf16 v[32:47], v[208:211], v[84:87], v[32:47]
  ds_read_b64_tr_b16 v[204:205], v5 offset:7168
  ds_read_b64_tr_b16 v[206:207], v5 offset:7680
  s_waitcnt lgkmcnt(8)
  v_mfma_f32_32x32x16_bf16 v[48:63], v[84:87], v[212:215], v[48:63]
  s_barrier
  ds_read_b64_tr_b16 v[208:209], v4 offset:40960
  ds_read_b64_tr_b16 v[210:211], v4 offset:41472
  s_waitcnt vmcnt(15)
  buffer_load_dwordx4 v[120:123], v1, s[8:11], s61 offen offset:2048 sc1
  s_waitcnt lgkmcnt(8)
  v_mfma_f32_32x32x16_bf16 v[32:47], v[192:195], v[88:91], v[32:47]
  ds_read_b64_tr_b16 v[212:213], v5 offset:8192
  ds_read_b64_tr_b16 v[214:215], v5 offset:8704
  s_waitcnt lgkmcnt(8)
  v_mfma_f32_32x32x16_bf16 v[48:63], v[88:91], v[196:199], v[48:63]
  ds_read_b64_tr_b16 v[192:193], v4 offset:41984
  ds_read_b64_tr_b16 v[194:195], v4 offset:42496
  s_waitcnt vmcnt(15)
  buffer_load_dwordx4 v[124:127], v1, s[8:11], s61 offen offset:3072 sc1
  s_waitcnt lgkmcnt(8)
  v_mfma_f32_32x32x16_bf16 v[32:47], v[200:203], v[92:95], v[32:47]
  ds_read_b64_tr_b16 v[196:197], v5 offset:9216
  ds_read_b64_tr_b16 v[198:199], v5 offset:9728
  s_waitcnt lgkmcnt(8)
  v_mfma_f32_32x32x16_bf16 v[48:63], v[92:95], v[204:207], v[48:63]
  ds_read_b64_tr_b16 v[200:201], v4 offset:43008
  ds_read_b64_tr_b16 v[202:203], v4 offset:43520
  s_waitcnt vmcnt(7)
  s_add_u32 s61, s61, 4096
  buffer_load_dwordx4 v[128:131], v1, s[8:11], s61 offen offset:0 sc1
  s_waitcnt lgkmcnt(8)
  v_mfma_f32_32x32x16_bf16 v[32:47], v[208:211], v[96:99], v[32:47]
  ds_read_b64_tr_b16 v[204:205], v5 offset:10240
  ds_read_b64_tr_b16 v[206:207], v5 offset:10752
  v_pk_add_f32 v[216:217], v[216:217], v[218:219]
  v_pk_add_f32 v[220:221], v[220:221], v[222:223]
  v_pk_add_f32 v[224:225], v[224:225], v[226:227]
  v_pk_add_f32 v[228:229], v[228:229], v[230:231]
  v_pk_add_f32 v[216:217], v[216:217], v[220:221]
  v_pk_add_f32 v[224:225], v[224:225], v[228:229]
  v_pk_add_f32 v[216:217], v[216:217], v[224:225]
  v_mov_b32 v218, v216
  v_mov_b32 v219, v217
  s_nop 1
  v_permlane32_swap_b32 v218, v216
  v_permlane32_swap_b32 v219, v217
  s_nop 0
  v_pk_add_f32 v[216:217], v[216:217], v[218:219]
  v_mul_f32 v216, 0x3b000000, v216
  v_mul_f32 v217, 0x3b000000, v217
  v_fma_f32 v217, -v216, v216, v217
  v_max_f32 v217, 0, v217
  v_add_f32 v217, 0x3727c5ac, v217
  v_rsq_f32 v8, v217
  s_nop 0
  v_mul_f32 v10, v216, v8
  v_and_b32 v6, 31, v0
  v_lshlrev_b32 v6, 2, v6
  v_add_u32 v13, 162048, v6
  s_lshl_b32 s52, s46, 8
  s_add_u32 s52, s52, 147456
  v_add_u32 v6, s52, v6
  ds_write_b32 v6, v8
  ds_write_b32 v6, v10 offset:128
  v_lshrrev_b32 v7, 5, v0
  v_lshlrev_b32 v7, 4, v7
  v_add_u32 v6, 161792, v7
  v_add_u32 v7, s52, v7
  s_waitcnt lgkmcnt(10)
  v_mfma_f32_32x32x16_bf16 v[48:63], v[96:99], v[212:215], v[48:63]
  ds_read_b64_tr_b16 v[208:209], v4 offset:44032
  ds_read_b64_tr_b16 v[210:211], v4 offset:44544
  s_waitcnt vmcnt(7)
  buffer_load_dwordx4 v[132:135], v1, s[8:11], s61 offen offset:1024 sc1
  s_waitcnt lgkmcnt(10)
  v_mfma_f32_32x32x16_bf16 v[32:47], v[192:195], v[100:103], v[32:47]
  ds_read_b64_tr_b16 v[212:213], v5 offset:11264
  ds_read_b64_tr_b16 v[214:215], v5 offset:11776
  s_waitcnt lgkmcnt(10)
  v_mfma_f32_32x32x16_bf16 v[48:63], v[100:103], v[196:199], v[48:63]
  ds_read_b64_tr_b16 v[192:193], v4 offset:45056
  ds_read_b64_tr_b16 v[194:195], v4 offset:45568
  s_waitcnt vmcnt(7)
  buffer_load_dwordx4 v[136:139], v1, s[8:11], s61 offen offset:2048 sc1
  s_waitcnt lgkmcnt(10)
  v_mfma_f32_32x32x16_bf16 v[32:47], v[200:203], v[104:107], v[32:47]
  ds_read_b64_tr_b16 v[196:197], v5 offset:12288
  ds_read_b64_tr_b16 v[198:199], v5 offset:12800
  s_waitcnt lgkmcnt(10)
  v_mfma_f32_32x32x16_bf16 v[48:63], v[104:107], v[204:207], v[48:63]
  ds_read_b64_tr_b16 v[200:201], v4 offset:46080
  ds_read_b64_tr_b16 v[202:203], v4 offset:46592
  s_waitcnt vmcnt(7)
  buffer_load_dwordx4 v[140:143], v1, s[8:11], s61 offen offset:3072 sc1
  s_waitcnt lgkmcnt(8)
  v_mfma_f32_32x32x16_bf16 v[32:47], v[208:211], v[108:111], v[32:47]
  ds_read_b64_tr_b16 v[204:205], v5 offset:13312
  ds_read_b64_tr_b16 v[206:207], v5 offset:13824
  s_waitcnt lgkmcnt(8)
  v_mfma_f32_32x32x16_bf16 v[48:63], v[108:111], v[212:215], v[48:63]
  ds_read_b64_tr_b16 v[208:209], v4 offset:47104
  ds_read_b64_tr_b16 v[210:211], v4 offset:47616
  s_waitcnt vmcnt(7)
  s_add_u32 s61, s61, 4096
  buffer_load_dwordx4 v[144:147], v1, s[8:11], s61 offen offset:0 sc1
  s_waitcnt lgkmcnt(8)
  v_mfma_f32_32x32x16_bf16 v[32:47], v[192:195], v[112:115], v[32:47]
  ds_read_b64_tr_b16 v[212:213], v5 offset:14336
  ds_read_b64_tr_b16 v[214:215], v5 offset:14848
  s_waitcnt lgkmcnt(8)
  v_mfma_f32_32x32x16_bf16 v[48:63], v[112:115], v[196:199], v[48:63]
  ds_read_b64_tr_b16 v[192:193], v4 offset:48128
  ds_read_b64_tr_b16 v[194:195], v4 offset:48640
  s_waitcnt vmcnt(7)
  buffer_load_dwordx4 v[148:151], v1, s[8:11], s61 offen offset:1024 sc1
  s_waitcnt lgkmcnt(8)
  v_mfma_f32_32x32x16_bf16 v[32:47], v[200:203], v[116:119], v[32:47]
  ds_read_b64_tr_b16 v[196:197], v5 offset:15360
  ds_read_b64_tr_b16 v[198:199], v5 offset:15872
  s_waitcnt lgkmcnt(8)
  v_mfma_f32_32x32x16_bf16 v[48:63], v[116:119], v[204:207], v[48:63]
  s_barrier
  ds_read_b64_tr_b16 v[200:201], v4 offset:49152
  ds_read_b64_tr_b16 v[202:203], v4 offset:49664
  s_waitcnt vmcnt(7)
  buffer_load_dwordx4 v[152:155], v1, s[8:11], s61 offen offset:2048 sc1
  s_waitcnt lgkmcnt(8)
  v_mfma_f32_32x32x16_bf16 v[32:47], v[208:211], v[120:123], v[32:47]
  ds_read_b64_tr_b16 v[204:205], v5 offset:16384
  ds_read_b64_tr_b16 v[206:207], v5 offset:16896
  s_waitcnt lgkmcnt(8)
  v_mfma_f32_32x32x16_bf16 v[48:63], v[120:123], v[212:215], v[48:63]
  ds_read_b64_tr_b16 v[208:209], v4 offset:50176
  ds_read_b64_tr_b16 v[210:211], v4 offset:50688
  s_waitcnt vmcnt(7)
  buffer_load_dwordx4 v[156:159], v1, s[8:11], s61 offen offset:3072 sc1
  s_waitcnt lgkmcnt(8)
  v_mfma_f32_32x32x16_bf16 v[32:47], v[192:195], v[124:127], v[32:47]
  ds_read_b64_tr_b16 v[212:213], v5 offset:17408
  ds_read_b64_tr_b16 v[214:215], v5 offset:17920
  s_waitcnt lgkmcnt(8)
  v_mfma_f32_32x32x16_bf16 v[48:63], v[124:127], v[196:199], v[48:63]
  ds_read_b64_tr_b16 v[192:193], v4 offset:51200
  ds_read_b64_tr_b16 v[194:195], v4 offset:51712
  s_waitcnt vmcnt(7)
  s_add_u32 s61, s61, 4096
  buffer_load_dwordx4 v[160:163], v1, s[8:11], s61 offen offset:0 sc1
  s_waitcnt lgkmcnt(8)
  v_mfma_f32_32x32x16_bf16 v[32:47], v[200:203], v[128:131], v[32:47]
  ds_read_b64_tr_b16 v[196:197], v5 offset:18432
  ds_read_b64_tr_b16 v[198:199], v5 offset:18944
  s_waitcnt lgkmcnt(8)
  v_mfma_f32_32x32x16_bf16 v[48:63], v[128:131], v[204:207], v[48:63]
  ds_read_b64_tr_b16 v[200:201], v4 offset:52224
  ds_read_b64_tr_b16 v[202:203], v4 offset:52736
  s_waitcnt vmcnt(7)
  buffer_load_dwordx4 v[164:167], v1, s[8:11], s61 offen offset:1024 sc1
  s_waitcnt lgkmcnt(8)
  v_mfma_f32_32x32x16_bf16 v[32:47], v[208:211], v[132:135], v[32:47]
  ds_read_b64_tr_b16 v[204:205], v5 offset:19456
  ds_read_b64_tr_b16 v[206:207], v5 offset:19968
  s_waitcnt lgkmcnt(8)
  v_mfma_f32_32x32x16_bf16 v[48:63], v[132:135], v[212:215], v[48:63]
  ds_read_b64_tr_b16 v[208:209], v4 offset:53248
  ds_read_b64_tr_b16 v[210:211], v4 offset:53760
  s_waitcnt vmcnt(7)
  buffer_load_dwordx4 v[168:171], v1, s[8:11], s61 offen offset:2048 sc1
  s_waitcnt lgkmcnt(8)
  v_mfma_f32_32x32x16_bf16 v[32:47], v[192:195], v[136:139], v[32:47]
  ds_read_b64_tr_b16 v[212:213], v5 offset:20480
  ds_read_b64_tr_b16 v[214:215], v5 offset:20992
  s_waitcnt lgkmcnt(8)
  v_mfma_f32_32x32x16_bf16 v[48:63], v[136:139], v[196:199], v[48:63]
  ds_read_b64_tr_b16 v[192:193], v4 offset:54272
  ds_read_b64_tr_b16 v[194:195], v4 offset:54784
  s_waitcnt vmcnt(7)
  buffer_load_dwordx4 v[172:175], v1, s[8:11], s61 offen offset:3072 sc1
  s_waitcnt lgkmcnt(8)
  v_mfma_f32_32x32x16_bf16 v[32:47], v[200:203], v[140:143], v[32:47]
  ds_read_b64_tr_b16 v[196:197], v5 offset:21504
  ds_read_b64_tr_b16 v[198:199], v5 offset:22016
  s_waitcnt lgkmcnt(8)
  v_mfma_f32_32x32x16_bf16 v[48:63], v[140:143], v[204:207], v[48:63]
  ds_read_b64_tr_b16 v[200:201], v4 offset:55296
  ds_read_b64_tr_b16 v[202:203], v4 offset:55808
  s_waitcnt vmcnt(7)
  s_add_u32 s61, s61, 4096
  buffer_load_dwordx4 v[176:179], v1, s[8:11], s61 offen offset:0 sc1
  s_waitcnt lgkmcnt(8)
  v_mfma_f32_32x32x16_bf16 v[32:47], v[208:211], v[144:147], v[32:47]
  ds_read_b64_tr_b16 v[204:205], v5 offset:22528
  ds_read_b64_tr_b16 v[206:207], v5 offset:23040
  s_waitcnt lgkmcnt(8)
  v_mfma_f32_32x32x16_bf16 v[48:63], v[144:147], v[212:215], v[48:63]
  ds_read_b64_tr_b16 v[208:209], v4 offset:56320
  ds_read_b64_tr_b16 v[210:211], v4 offset:56832
  s_waitcnt vmcnt(7)
  buffer_load_dwordx4 v[180:183], v1, s[8:11], s61 offen offset:1024 sc1
  s_waitcnt lgkmcnt(8)
  v_mfma_f32_32x32x16_bf16 v[32:47], v[192:195], v[148:151], v[32:47]
  ds_read_b64_tr_b16 v[212:213], v5 offset:23552
  ds_read_b64_tr_b16 v[214:215], v5 offset:24064
  s_waitcnt lgkmcnt(8)
  v_mfma_f32_32x32x16_bf16 v[48:63], v[148:151], v[196:199], v[48:63]
  s_barrier
  ds_read_b64_tr_b16 v[192:193], v4 offset:57344
  ds_read_b64_tr_b16 v[194:195], v4 offset:57856
  s_waitcnt vmcnt(7)
  buffer_load_dwordx4 v[184:187], v1, s[8:11], s61 offen offset:2048 sc1
  s_waitcnt lgkmcnt(8)
  v_mfma_f32_32x32x16_bf16 v[32:47], v[200:203], v[152:155], v[32:47]
  ds_read_b64_tr_b16 v[196:197], v5 offset:24576
  ds_read_b64_tr_b16 v[198:199], v5 offset:25088
  s_waitcnt lgkmcnt(8)
  v_mfma_f32_32x32x16_bf16 v[48:63], v[152:155], v[204:207], v[48:63]
  ds_read_b64_tr_b16 v[200:201], v4 offset:58368
  ds_read_b64_tr_b16 v[202:203], v4 offset:58880
  s_waitcnt vmcnt(7)
  buffer_load_dwordx4 v[188:191], v1, s[8:11], s61 offen offset:3072 sc1
  s_waitcnt lgkmcnt(8)
  v_mfma_f32_32x32x16_bf16 v[32:47], v[208:211], v[156:159], v[32:47]
  ds_read_b64_tr_b16 v[204:205], v5 offset:25600
  ds_read_b64_tr_b16 v[206:207], v5 offset:26112
  s_waitcnt lgkmcnt(8)
  v_mfma_f32_32x32x16_bf16 v[48:63], v[156:159], v[212:215], v[48:63]
  ds_read_b64_tr_b16 v[208:209], v4 offset:59392
  ds_read_b64_tr_b16 v[210:211], v4 offset:59904
  s_waitcnt vmcnt(7)
  s_waitcnt lgkmcnt(8)
  v_mfma_f32_32x32x16_bf16 v[32:47], v[192:195], v[160:163], v[32:47]
  ds_read_b64_tr_b16 v[212:213], v5 offset:26624
  ds_read_b64_tr_b16 v[214:215], v5 offset:27136
  s_waitcnt lgkmcnt(8)
  v_mfma_f32_32x32x16_bf16 v[48:63], v[160:163], v[196:199], v[48:63]
  ds_read_b64_tr_b16 v[192:193], v4 offset:60416
  ds_read_b64_tr_b16 v[194:195], v4 offset:60928
  s_waitcnt vmcnt(6)
  s_waitcnt lgkmcnt(8)
  v_mfma_f32_32x32x16_bf16 v[32:47], v[200:203], v[164:167], v[32:47]
  ds_read_b64_tr_b16 v[196:197], v5 offset:27648
  ds_read_b64_tr_b16 v[198:199], v5 offset:28160
  s_waitcnt lgkmcnt(8)
  v_mfma_f32_32x32x16_bf16 v[48:63], v[164:167], v[204:207], v[48:63]
  ds_read_b64_tr_b16 v[200:201], v4 offset:61440
  ds_read_b64_tr_b16 v[202:203], v4 offset:61952
  s_waitcnt vmcnt(5)
  s_waitcnt lgkmcnt(8)
  v_mfma_f32_32x32x16_bf16 v[32:47], v[208:211], v[168:171], v[32:47]
  ds_read_b64_tr_b16 v[204:205], v5 offset:28672
  ds_read_b64_tr_b16 v[206:207], v5 offset:29184
  s_waitcnt lgkmcnt(8)
  v_mfma_f32_32x32x16_bf16 v[48:63], v[168:171], v[212:215], v[48:63]
  ds_read_b64_tr_b16 v[208:209], v4 offset:62464
  ds_read_b64_tr_b16 v[210:211], v4 offset:62976
  s_waitcnt vmcnt(4)
  s_waitcnt lgkmcnt(8)
  v_mfma_f32_32x32x16_bf16 v[32:47], v[192:195], v[172:175], v[32:47]
  ds_read_b64_tr_b16 v[212:213], v5 offset:29696
  ds_read_b64_tr_b16 v[214:215], v5 offset:30208
  s_waitcnt lgkmcnt(8)
  v_mfma_f32_32x32x16_bf16 v[48:63], v[172:175], v[196:199], v[48:63]
  ds_read_b64_tr_b16 v[192:193], v4 offset:63488
  ds_read_b64_tr_b16 v[194:195], v4 offset:64000
  s_waitcnt vmcnt(3)
  s_waitcnt lgkmcnt(8)
  v_mfma_f32_32x32x16_bf16 v[32:47], v[200:203], v[176:179], v[32:47]
  ds_read_b64_tr_b16 v[196:197], v5 offset:30720
  ds_read_b64_tr_b16 v[198:199], v5 offset:31232
  s_waitcnt lgkmcnt(8)
  v_mfma_f32_32x32x16_bf16 v[48:63], v[176:179], v[204:207], v[48:63]
  ds_read_b64_tr_b16 v[200:201], v4 offset:64512
  ds_read_b64_tr_b16 v[202:203], v4 offset:65024
  s_waitcnt vmcnt(2)
  s_waitcnt lgkmcnt(8)
  v_mfma_f32_32x32x16_bf16 v[32:47], v[208:211], v[180:183], v[32:47]
  ds_read_b64_tr_b16 v[204:205], v5 offset:31744
  ds_read_b64_tr_b16 v[206:207], v5 offset:32256
  s_waitcnt lgkmcnt(8)
  v_mfma_f32_32x32x16_bf16 v[48:63], v[180:183], v[212:215], v[48:63]
  ds_read_b64_tr_b16 v[208:209], v4 offset:0
  ds_read_b64_tr_b16 v[210:211], v4 offset:512
  s_waitcnt vmcnt(1)
  s_waitcnt lgkmcnt(8)
  v_mfma_f32_32x32x16_bf16 v[32:47], v[192:195], v[184:187], v[32:47]
  ds_read_b64_tr_b16 v[212:213], v4 offset:1024
  ds_read_b64_tr_b16 v[214:215], v4 offset:1536
  s_waitcnt lgkmcnt(8)
  v_mfma_f32_32x32x16_bf16 v[48:63], v[184:187], v[196:199], v[48:63]
  ds_read_b64_tr_b16 v[192:193], v4 offset:2048
  ds_read_b64_tr_b16 v[194:195], v4 offset:2560
  s_waitcnt vmcnt(0)
  s_waitcnt lgkmcnt(8)
  v_mfma_f32_32x32x16_bf16 v[32:47], v[200:203], v[188:191], v[32:47]
  ds_read_b64_tr_b16 v[196:197], v4 offset:3072
  ds_read_b64_tr_b16 v[198:199], v4 offset:3584
  s_waitcnt lgkmcnt(8)
  v_mfma_f32_32x32x16_bf16 v[48:63], v[188:191], v[204:207], v[48:63]
  ds_read_b64_tr_b16 v[200:201], v4 offset:4096
  ds_read_b64_tr_b16 v[202:203], v4 offset:4608
L_p1_passB:
  v_mov_b32 v14, 0
  buffer_load_dword v15, v14, s[36:39], 0 offen sc1
  s_lshl_b32 s56, s44, 2
  s_add_u32 s56, s56, s46
  s_lshl_b32 s52, s56, 15
  s_lshl_b32 s53, s45, 11
  s_add_u32 s52, s52, s53
  s_add_u32 s52, s52, s94
  s_add_u32 s53, s52, 12582912
  s_add_u32 s52, s52, 8388608
  ds_read_b32 v12, v13
  ds_read_b128 v[232:235], v6 offset:128
  ds_read_b128 v[240:243], v6 offset:160
  s_waitcnt lgkmcnt(11)
  v_mfma_f32_32x32x16_bf16 v[16:31], v[208:211], v[64:67], 0
  ds_read_b64_tr_b16 v[204:205], v4 offset:5120
  ds_read_b64_tr_b16 v[206:207], v4 offset:5632
  s_nop 9
  s_waitcnt lgkmcnt(11)
  v_mfma_f32_32x32x16_bf16 v[16:31], v[212:215], v[68:71], v[16:31]
  ds_read_b64_tr_b16 v[208:209], v4 offset:6144
  ds_read_b64_tr_b16 v[210:211], v4 offset:6656
  s_waitcnt lgkmcnt(5)
  v_mul_f32 v32, v32, v8
  v_fma_f32 v32, -v10, v232, v32
  v_mul_f32 v33, v33, v8
  v_fma_f32 v33, -v10, v233, v33
  s_waitcnt lgkmcnt(11)
  v_mfma_f32_32x32x16_bf16 v[16:31], v[192:195], v[72:75], v[16:31]
  ds_read_b64_tr_b16 v[212:213], v4 offset:7168
  ds_read_b64_tr_b16 v[214:215], v4 offset:7680
  v_mul_f32 v34, v34, v8
  v_fma_f32 v34, -v10, v234, v34
  v_mul_f32 v35, v35, v8
  v_fma_f32 v35, -v10, v235, v35
  s_waitcnt lgkmcnt(11)
  v_mfma_f32_32x32x16_bf16 v[16:31], v[196:199], v[76:79], v[16:31]
  ds_read_b64_tr_b16 v[192:193], v4 offset:8192
  ds_read_b64_tr_b16 v[194:195], v4 offset:8704
  ds_read_b128 v[232:235], v6 offset:192
  v_cvt_pk_bf16_f32 v32, v32, v33
  v_cvt_pk_bf16_f32 v33, v34, v35
  s_waitcnt lgkmcnt(9)
  v_mul_f32 v36, v36, v8
  v_fma_f32 v36, -v10, v240, v36
  s_waitcnt lgkmcnt(12)
  v_mfma_f32_32x32x16_bf16 v[16:31], v[200:203], v[80:83], v[16:31]
  ds_read_b64_tr_b16 v[196:197], v4 offset:9216
  ds_read_b64_tr_b16 v[198:199], v4 offset:9728
  v_mul_f32 v37, v37, v8
  v_fma_f32 v37, -v10, v241, v37
  v_mul_f32 v38, v38, v8
  v_fma_f32 v38, -v10, v242, v38
  s_waitcnt lgkmcnt(9)
  v_mfma_f32_32x32x16_bf16 v[16:31], v[204:207], v[84:87], v[16:31]
  ds_read_b64_tr_b16 v[200:201], v4 offset:10240
  ds_read_b64_tr_b16 v[202:203], v4 offset:10752
  v_mul_f32 v39, v39, v8
  v_fma_f32 v39, -v10, v243, v39
  ds_read_b128 v[240:243], v6 offset:224
  v_cvt_pk_bf16_f32 v34, v36, v37
  v_cvt_pk_bf16_f32 v35, v38, v39
  s_waitcnt lgkmcnt(10)
  v_mfma_f32_32x32x16_bf16 v[16:31], v[208:211], v[88:91], v[16:31]
  ds_read_b64_tr_b16 v[204:205], v4 offset:11264
  ds_read_b64_tr_b16 v[206:207], v4 offset:11776
  s_waitcnt lgkmcnt(7)
  v_mul_f32 v40, v40, v8
  v_fma_f32 v40, -v10, v232, v40
  v_mul_f32 v41, v41, v8
  v_fma_f32 v41, -v10, v233, v41
  s_waitcnt lgkmcnt(10)
  v_mfma_f32_32x32x16_bf16 v[16:31], v[212:215], v[92:95], v[16:31]
  ds_read_b64_tr_b16 v[208:209], v4 offset:12288
  ds_read_b64_tr_b16 v[210:211], v4 offset:12800
  v_mul_f32 v42, v42, v8
  v_fma_f32 v42, -v10, v234, v42
  v_mul_f32 v43, v43, v8
  v_fma_f32 v43, -v10, v235, v43
  s_waitcnt lgkmcnt(10)
  v_mfma_f32_32x32x16_bf16 v[16:31], v[192:195], v[96:99], v[16:31]
  ds_read_b64_tr_b16 v[212:213], v4 offset:13312
  ds_read_b64_tr_b16 v[214:215], v4 offset:13824
  ds_read_b128 v[232:235], v7 offset:0
  ds_read_b128 v[236:239], v7 offset:128
  v_cvt_pk_bf16_f32 v36, v40, v41
  v_cvt_pk_bf16_f32 v37, v42, v43
  s_waitcnt lgkmcnt(8)
  v_mul_f32 v44, v44, v8
  v_fma_f32 v44, -v10, v240, v44
  s_waitcnt lgkmcnt(11)
  v_mfma_f32_32x32x16_bf16 v[16:31], v[196:199], v[100:103], v[16:31]
  ds_read_b64_tr_b16 v[192:193], v4 offset:14336
  ds_read_b64_tr_b16 v[194:195], v4 offset:14848
  v_mul_f32 v45, v45, v8
  v_fma_f32 v45, -v10, v241, v45
  v_mul_f32 v46, v46, v8
  v_fma_f32 v46, -v10, v242, v46
  s_waitcnt lgkmcnt(11)
  v_mfma_f32_32x32x16_bf16 v[16:31], v[200:203], v[104:107], v[16:31]
  ds_read_b64_tr_b16 v[196:197], v4 offset:15360
  ds_read_b64_tr_b16 v[198:199], v4 offset:15872
  v_mul_f32 v47, v47, v8
  v_fma_f32 v47, -v10, v243, v47
  ds_read_b128 v[240:243], v7 offset:32
  ds_read_b128 v[244:247], v7 offset:160
  v_cvt_pk_bf16_f32 v38, v44, v45
  v_cvt_pk_bf16_f32 v39, v46, v47
  s_waitcnt lgkmcnt(12)
  v_mfma_f32_32x32x16_bf16 v[16:31], v[204:207], v[108:111], v[16:31]
  ds_read_b64_tr_b16 v[200:201], v4 offset:16384
  ds_read_b64_tr_b16 v[202:203], v4 offset:16896
  buffer_store_dwordx4 v[32:35], v1, s[8:11], s52 offen sc1
  buffer_store_dwordx4 v[36:39], v1, s[8:11], s52 offen offset:1024 sc1
  s_waitcnt lgkmcnt(8)
  v_mul_f32 v48, v48, v232
  v_fma_f32 v48, -v236, v12, v48
  v_mul_f32 v49, v49, v233
  v_fma_f32 v49, -v237, v12, v49
  s_waitcnt lgkmcnt(12)
  v_mfma_f32_32x32x16_bf16 v[16:31], v[208:211], v[112:115], v[16:31]
  ds_read_b64_tr_b16 v[204:205], v4 offset:17408
  ds_read_b64_tr_b16 v[206:207], v4 offset:17920
  v_mul_f32 v50, v50, v234
  v_fma_f32 v50, -v238, v12, v50
  v_mul_f32 v51, v51, v235
  v_fma_f32 v51, -v239, v12, v51
  s_waitcnt lgkmcnt(12)
  v_mfma_f32_32x32x16_bf16 v[16:31], v[212:215], v[116:119], v[16:31]
  ds_read_b64_tr_b16 v[208:209], v4 offset:18432
  ds_read_b64_tr_b16 v[210:211], v4 offset:18944
  ds_read_b128 v[232:235], v7 offset:64
  ds_read_b128 v[236:239], v7 offset:192
  v_cvt_pk_bf16_f32 v48, v48, v49
  v_cvt_pk_bf16_f32 v49, v50, v51
  s_waitcnt lgkmcnt(8)
  v_mul_f32 v52, v52, v240
  v_fma_f32 v52, -v244, v12, v52
  s_waitcnt lgkmcnt(12)
  v_mfma_f32_32x32x16_bf16 v[16:31], v[192:195], v[120:123], v[16:31]
  ds_read_b64_tr_b16 v[212:213], v4 offset:19456
  ds_read_b64_tr_b16 v[214:215], v4 offset:19968
  v_mul_f32 v53, v53, v241
  v_fma_f32 v53, -v245, v12, v53
  v_mul_f32 v54, v54, v242
  v_fma_f32 v54, -v246, v12, v54
  s_waitcnt lgkmcnt(12)
  v_mfma_f32_32x32x16_bf16 v[16:31], v[196:199], v[124:127], v[16:31]
  ds_read_b64_tr_b16 v[192:193], v4 offset:20480
  ds_read_b64_tr_b16 v[194:195], v4 offset:20992
  v_mul_f32 v55, v55, v243
  v_fma_f32 v55, -v247, v12, v55
  ds_read_b128 v[240:243], v7 offset:96
  ds_read_b128 v[244:247], v7 offset:224
  v_cvt_pk_bf16_f32 v50, v52, v53
  v_cvt_pk_bf16_f32 v51, v54, v55
  s_waitcnt lgkmcnt(12)
  v_mfma_f32_32x32x16_bf16 v[16:31], v[200:203], v[128:131], v[16:31]
  ds_read_b64_tr_b16 v[196:197], v4 offset:21504
  ds_read_b64_tr_b16 v[198:199], v4 offset:22016
  s_waitcnt lgkmcnt(8)
  v_mul_f32 v56, v56, v232
  v_fma_f32 v56, -v236, v12, v56
  v_mul_f32 v57, v57, v233
  v_fma_f32 v57, -v237, v12, v57
  s_waitcnt lgkmcnt(12)
  v_mfma_f32_32x32x16_bf16 v[16:31], v[204:207], v[132:135], v[16:31]
  ds_read_b64_tr_b16 v[200:201], v4 offset:22528
  ds_read_b64_tr_b16 v[202:203], v4 offset:23040
  v_mul_f32 v58, v58, v234
  v_fma_f32 v58, -v238, v12, v58
  v_mul_f32 v59, v59, v235
  v_fma_f32 v59, -v239, v12, v59
  s_waitcnt lgkmcnt(12)
  v_mfma_f32_32x32x16_bf16 v[16:31], v[208:211], v[136:139], v[16:31]
  ds_read_b64_tr_b16 v[204:205], v4 offset:23552
  ds_read_b64_tr_b16 v[206:207], v4 offset:24064
  v_cvt_pk_bf16_f32 v52, v56, v57
  v_cvt_pk_bf16_f32 v53, v58, v59
  s_waitcnt lgkmcnt(6)
  v_mul_f32 v60, v60, v240
  v_fma_f32 v60, -v244, v12, v60
  s_waitcnt lgkmcnt(10)
  v_mfma_f32_32x32x16_bf16 v[16:31], v[212:215], v[140:143], v[16:31]
  ds_read_b64_tr_b16 v[208:209], v4 offset:24576
  ds_read_b64_tr_b16 v[210:211], v4 offset:25088
  v_mul_f32 v61, v61, v241
  v_fma_f32 v61, -v245, v12, v61
  v_mul_f32 v62, v62, v242
  v_fma_f32 v62, -v246, v12, v62
  s_waitcnt lgkmcnt(10)
  v_mfma_f32_32x32x16_bf16 v[16:31], v[192:195], v[144:147], v[16:31]
  ds_read_b64_tr_b16 v[212:213], v4 offset:25600
  ds_read_b64_tr_b16 v[214:215], v4 offset:26112
  v_mul_f32 v63, v63, v243
  v_fma_f32 v63, -v247, v12, v63
  v_cvt_pk_bf16_f32 v54, v60, v61
  v_cvt_pk_bf16_f32 v55, v62, v63
  s_waitcnt lgkmcnt(8)
  v_mfma_f32_32x32x16_bf16 v[16:31], v[196:199], v[148:151], v[16:31]
  ds_read_b64_tr_b16 v[192:193], v4 offset:26624
  ds_read_b64_tr_b16 v[194:195], v4 offset:27136
  buffer_store_dwordx4 v[48:51], v1, s[8:11], s53 offen sc1
  buffer_store_dwordx4 v[52:55], v1, s[8:11], s53 offen offset:1024 sc1
  s_waitcnt lgkmcnt(8)
  v_mfma_f32_32x32x16_bf16 v[16:31], v[200:203], v[152:155], v[16:31]
  ds_read_b64_tr_b16 v[196:197], v4 offset:27648
  ds_read_b64_tr_b16 v[198:199], v4 offset:28160
  s_waitcnt lgkmcnt(8)
  v_mfma_f32_32x32x16_bf16 v[16:31], v[204:207], v[156:159], v[16:31]
  ds_read_b64_tr_b16 v[200:201], v4 offset:28672
  ds_read_b64_tr_b16 v[202:203], v4 offset:29184
  s_waitcnt lgkmcnt(8)
  v_mfma_f32_32x32x16_bf16 v[16:31], v[208:211], v[160:163], v[16:31]
  ds_read_b64_tr_b16 v[204:205], v4 offset:29696
  ds_read_b64_tr_b16 v[206:207], v4 offset:30208
  s_waitcnt lgkmcnt(8)
  v_mfma_f32_32x32x16_bf16 v[16:31], v[212:215], v[164:167], v[16:31]
  ds_read_b64_tr_b16 v[208:209], v4 offset:30720
  ds_read_b64_tr_b16 v[210:211], v4 offset:31232
  s_waitcnt lgkmcnt(8)
  v_mfma_f32_32x32x16_bf16 v[16:31], v[192:195], v[168:171], v[16:31]
  ds_read_b64_tr_b16 v[212:213], v4 offset:31744
  ds_read_b64_tr_b16 v[214:215], v4 offset:32256
  s_waitcnt lgkmcnt(8)
  v_mfma_f32_32x32x16_bf16 v[16:31], v[196:199], v[172:175], v[16:31]
  s_waitcnt lgkmcnt(6)
  v_mfma_f32_32x32x16_bf16 v[16:31], v[200:203], v[176:179], v[16:31]
  s_waitcnt lgkmcnt(4)
  v_mfma_f32_32x32x16_bf16 v[16:31], v[204:207], v[180:183], v[16:31]
  s_waitcnt lgkmcnt(2)
  v_mfma_f32_32x32x16_bf16 v[16:31], v[208:211], v[184:187], v[16:31]
  s_waitcnt lgkmcnt(0)
  v_mfma_f32_32x32x16_bf16 v[16:31], v[212:215], v[188:191], v[16:31]
  ds_read_b128 v[232:235], v6 offset:0
  ds_read_b128 v[236:239], v6 offset:32
  ds_read_b128 v[240:243], v6 offset:64
  ds_read_b128 v[244:247], v6 offset:96
  s_barrier
  s_waitcnt vmcnt(0)
  v_readfirstlane_b32 s95, v15
  s_cmp_lg_u32 s95, 0
  s_cbranch_scc1 L_havenonce_9
  v_mov_b32 v14, 0
  s_mov_b32 s91, 262144
L_npoll_10:
  buffer_load_dword v15, v14, s[36:39], 0 offen sc1
  s_waitcnt vmcnt(0)
  v_readfirstlane_b32 s95, v15
  s_cmp_lg_u32 s95, 0
  s_cbranch_scc1 L_ndone_11
  s_sleep 2
  s_sub_u32 s91, s91, 1
  s_cbranch_scc0 L_npoll_10
  s_mov_b32 s51, 1
L_ndone_11:
L_havenonce_9:
  s_lshl_b32 s52, s45, 7
  s_add_u32 s52, s52, s49
  s_lshl_b32 s53, s46, 3
  s_add_u32 s52, s52, s53
  s_add_u32 s52, s52, 1024
  s_add_u32 s53, s48, 1
  v_mov_b32 v14, s95
  v_mov_b32 v15, s53
  v_mov_b32 v13, 0
  s_mov_b64 exec, 1
  buffer_store_dwordx2 v[14:15], v13, s[8:11], s52 offen sc1
  s_mov_b64 exec, -1
  s_waitcnt lgkmcnt(0)
  v_mul_f32 v152, 0x3eb8aa3b, v8
  v_mul_f32 v154, 0x3eb8aa3b, v10
  v_pk_mul_f32 v[16:17], v[16:17], v[152:153] op_sel_hi:[1,0]
  v_pk_fma_f32 v[16:17], v[232:233], v[154:155], v[16:17] op_sel_hi:[1,0,1] neg_lo:[0,1,0] neg_hi:[0,1,0]
  v_pk_mul_f32 v[18:19], v[18:19], v[152:153] op_sel_hi:[1,0]
  v_pk_fma_f32 v[18:19], v[234:235], v[154:155], v[18:19] op_sel_hi:[1,0,1] neg_lo:[0,1,0] neg_hi:[0,1,0]
  v_pk_mul_f32 v[20:21], v[20:21], v[152:153] op_sel_hi:[1,0]
  v_pk_fma_f32 v[20:21], v[236:237], v[154:155], v[20:21] op_sel_hi:[1,0,1] neg_lo:[0,1,0] neg_hi:[0,1,0]
  v_pk_mul_f32 v[22:23], v[22:23], v[152:153] op_sel_hi:[1,0]
  v_pk_fma_f32 v[22:23], v[238:239], v[154:155], v[22:23] op_sel_hi:[1,0,1] neg_lo:[0,1,0] neg_hi:[0,1,0]
  v_pk_mul_f32 v[24:25], v[24:25], v[152:153] op_sel_hi:[1,0]
  v_pk_fma_f32 v[24:25], v[240:241], v[154:155], v[24:25] op_sel_hi:[1,0,1] neg_lo:[0,1,0] neg_hi:[0,1,0]
  v_pk_mul_f32 v[26:27], v[26:27], v[152:153] op_sel_hi:[1,0]
  v_pk_fma_f32 v[26:27], v[242:243], v[154:155], v[26:27] op_sel_hi:[1,0,1] neg_lo:[0,1,0] neg_hi:[0,1,0]
  v_pk_mul_f32 v[28:29], v[28:29], v[152:153] op_sel_hi:[1,0]
  v_pk_fma_f32 v[28:29], v[244:245], v[154:155], v[28:29] op_sel_hi:[1,0,1] neg_lo:[0,1,0] neg_hi:[0,1,0]
  v_pk_mul_f32 v[30:31], v[30:31], v[152:153] op_sel_hi:[1,0]
  v_pk_fma_f32 v[30:31], v[246:247], v[154:155], v[30:31] op_sel_hi:[1,0,1] neg_lo:[0,1,0] neg_hi:[0,1,0]
  v_cvt_pk_bf16_f32 v16, v16, v17
  v_cvt_pk_bf16_f32 v17, v18, v19
  v_cvt_pk_bf16_f32 v18, v20, v21
  v_cvt_pk_bf16_f32 v19, v22, v23
  v_cvt_pk_bf16_f32 v20, v24, v25
  v_cvt_pk_bf16_f32 v21, v26, v27
  v_cvt_pk_bf16_f32 v22, v28, v29
  v_cvt_pk_bf16_f32 v23, v30, v31
  s_lshl_b32 s54, s46, 11
  v_add_u32 v6, s54, v1
  ds_write_b128 v6, v[32:35] offset:16384
  ds_write_b128 v6, v[36:39] offset:17408
  ds_write_b128 v6, v[48:51] offset:40960
  ds_write_b128 v6, v[52:55] offset:41984
  ds_write_b128 v6, v[16:19] offset:49152
  ds_write_b128 v6, v[20:23] offset:50176
  s_lshr_b32 s52, s46, 1
  s_add_u32 s52, s52, s44
  s_sub_u32 s52, s52, 2
  s_cbranch_scc1 L_nokv_12
  s_lshl_b32 s52, s52, 12
  s_lshl_b32 s53, s45, 7
  s_add_u32 s52, s52, s53
  s_lshl_b32 s53, s46, 4
  s_and_b32 s53, s53, 16
  s_add_u32 s52, s52, s53
  s_add_u32 s52, s52, 1024
  v_and_b32 v10, 1, v0
  v_lshlrev_b32 v10, 3, v10
  s_add_u32 s90, s48, 1
  s_mov_b32 s91, 262144
  s_cmp_eq_u32 s51, 0
  s_cbranch_scc0 L_pdone_14
L_poll_13:
  buffer_load_dwordx2 v[12:13], v10, s[8:11], s52 offen sc1
  s_waitcnt vmcnt(0)
  v_subrev_u32 v14, s90, v13
  v_cmp_ne_u32 vcc, s95, v12
  v_cmp_lt_u32 s[62:63], 31, v14
  s_or_b64 vcc, vcc, s[62:63]
  s_cbranch_vccz L_pdone_14
  s_sleep 1
  s_sub_u32 s91, s91, 1
  s_cbranch_scc0 L_poll_13
  s_mov_b32 s51, 1
L_pdone_14:
  s_lshl_b32 s52, s44, 2
  s_lshl_b32 s53, s46, 1
  s_add_u32 s52, s52, s53
  s_add_u32 s52, s52, 0
  s_sub_u32 s52, s52, 8
  s_lshl_b32 s52, s52, 15
  s_lshl_b32 s54, s45, 11
  s_add_u32 s52, s52, s54
  s_add_u32 s52, s52, s94
  s_add_u32 s54, s52, 12582912
  s_add_u32 s52, s52, 8388608
  s_lshl_b32 s53, s46, 12
  s_add_u32 m0, s53, 0
  s_nop 0
  buffer_load_dwordx4 v1, s[8:11], s52 offen sc1 lds
  buffer_load_dwordx4 v1, s[8:11], s52 offen offset:1024 sc1 lds
  s_add_u32 m0, s53, 24576
  s_nop 0
  buffer_load_dwordx4 v1, s[8:11], s54 offen sc1 lds
  buffer_load_dwordx4 v1, s[8:11], s54 offen offset:1024 sc1 lds
  s_lshl_b32 s52, s44, 2
  s_lshl_b32 s53, s46, 1
  s_add_u32 s52, s52, s53
  s_add_u32 s52, s52, 1
  s_sub_u32 s52, s52, 8
  s_lshl_b32 s52, s52, 15
  s_lshl_b32 s54, s45, 11
  s_add_u32 s52, s52, s54
  s_add_u32 s52, s52, s94
  s_add_u32 s54, s52, 12582912
  s_add_u32 s52, s52, 8388608
  s_lshl_b32 s53, s46, 12
  s_add_u32 m0, s53, 2048
  s_nop 0
  buffer_load_dwordx4 v1, s[8:11], s52 offen sc1 lds
  buffer_load_dwordx4 v1, s[8:11], s52 offen offset:1024 sc1 lds
  s_add_u32 m0, s53, 26624
  s_nop 0
  buffer_load_dwordx4 v1, s[8:11], s54 offen sc1 lds
  buffer_load_dwordx4 v1, s[8:11], s54 offen offset:1024 sc1 lds
L_nokv_12:
  s_waitcnt vmcnt(0) lgkmcnt(0)
  s_barrier
  s_branch L_p2
L_pro_helper:
  s_cmp_lt_u32 s46, 5
  s_cbranch_scc1 L_skip_15
  v_lshrrev_b32 v2, 2, v0
  v_mul_u32_u24 v2, 3072, v2
  v_and_b32 v3, 3, v0
  v_lshl_add_u32 v2, v3, 4, v2
  s_sub_u32 s52, s46, 5
  s_lshl_b32 s53, s52, 10
  s_lshl_b32 s54, s45, 6
  s_add_u32 s53, s53, s54
  s_lshl_b32 s52, s52, 15
  s_add_u32 m0, s52, 0
  s_mov_b32 s91, 16
L_dma_16:
  buffer_load_dwordx4 v2, s[12:15], s53 offen lds
  s_add_u32 m0, m0, 1024
  s_add_u32 s53, s53, 49152
  s_sub_u32 s91, s91, 1
  s_cmp_lg_u32 s91, 0
  s_cbranch_scc1 L_dma_16
L_skip_15:
  s_cmp_lg_u32 s46, 4
  s_cbranch_scc1 L_noreg_17
  s_cmp_lg_u32 s2, 0
  s_cbranch_scc1 L_nononce_19
  s_memrealtime s[52:53]
  s_waitcnt lgkmcnt(0)
  s_or_b32 s52, s52, 1
  v_mov_b32 v4, s52
  v_mov_b32 v8, 0
  s_mov_b64 exec, 1
  buffer_store_dword v4, v8, s[36:39], 0 offen sc1
  s_mov_b64 exec, -1
L_nononce_19:
  s_cmp_lg_u32 s45, 0
  s_cbranch_scc1 L_noleader_18
  v_mov_b32 v4, 0
  v_lshlrev_b32 v5, 2, v0
  buffer_store_dword v4, v5, s[8:11], s49 offen sc1
L_noleader_18:
  v_lshrrev_b32 v56, 2, v0
  v_mul_u32_u24 v56, 3072, v56
  v_and_b32 v59, 3, v0
  v_lshl_add_u32 v56, v59, 4, v56
  v_lshrrev_b32 v57, 3, v0
  v_lshlrev_b32 v57, 10, v57
  v_lshrrev_b32 v59, 2, v0
  v_lshrrev_b32 v60, 4, v0
  v_xor_b32 v59, v59, v60
  v_and_b32 v59, 1, v59
  v_lshl_add_u32 v57, v59, 6, v57
  v_and_b32 v59, 3, v0
  v_lshl_add_u32 v57, v59, 4, v57
  v_lshrrev_b32 v58, 4, v0
  v_bfe_u32 v59, v0, 2, 2
  v_xor_b32 v59, v59, v58
  v_mul_u32_u24 v58, 3584, v58
  v_lshl_add_u32 v58, v59, 6, v58
  v_and_b32 v59, 3, v0
  v_lshl_add_u32 v58, v59, 4, v58
  s_lshr_b32 s52, s2, 4
  s_lshl_b32 s52, s52, 6
  s_and_b32 s53, s2, 15
  s_mul_i32 s53, s53, 6
  s_add_u32 s54, s53, 0
  s_lshr_b32 s55, s54, 5
  s_lshl_b32 s55, s55, 10
  s_and_b32 s54, s54, 31
  s_mul_i32 s54, s54, 49152
  s_add_u32 s54, s54, s55
  s_add_u32 s54, s54, s52
  buffer_load_dwordx4 v[64:67], v56, s[12:15], s54 offen
  s_add_u32 s54, s53, 1
  s_lshr_b32 s55, s54, 5
  s_lshl_b32 s55, s55, 10
  s_and_b32 s54, s54, 31
  s_mul_i32 s54, s54, 49152
  s_add_u32 s54, s54, s55
  s_add_u32 s54, s54, s52
  buffer_load_dwordx4 v[68:71], v56, s[12:15], s54 offen
  s_add_u32 s54, s53, 2
  s_lshr_b32 s55, s54, 5
  s_lshl_b32 s55, s55, 10
  s_and_b32 s54, s54, 31
  s_mul_i32 s54, s54, 49152
  s_add_u32 s54, s54, s55
  s_add_u32 s54, s54, s52
  buffer_load_dwordx4 v[72:75], v56, s[12:15], s54 offen
  s_add_u32 s54, s53, 3
  s_lshr_b32 s55, s54, 5
  s_lshl_b32 s55, s55, 10
  s_and_b32 s54, s54, 31
  s_mul_i32 s54, s54, 49152
  s_add_u32 s54, s54, s55
  s_add_u32 s54, s54, s52
  buffer_load_dwordx4 v[76:79], v56, s[12:15], s54 offen
  s_add_u32 s54, s53, 4
  s_lshr_b32 s55, s54, 5
  s_lshl_b32 s55, s55, 10
  s_and_b32 s54, s54, 31
  s_mul_i32 s54, s54, 49152
  s_add_u32 s54, s54, s55
  s_add_u32 s54, s54, s52
  buffer_load_dwordx4 v[80:83], v56, s[12:15], s54 offen
  s_add_u32 s54, s53, 5
  s_lshr_b32 s55, s54, 5
  s_lshl_b32 s55, s55, 10
  s_and_b32 s54, s54, 31
  s_mul_i32 s54, s54, 49152
  s_add_u32 s54, s54, s55
  s_add_u32 s54, s54, s52
  buffer_load_dwordx4 v[84:87], v56, s[12:15], s54 offen
  s_lshr_b32 s52, s2, 5
  s_lshl_b32 s52, s52, 7
  s_and_b32 s53, s2, 31
  s_lshl_b32 s54, s53, 14
  s_add_u32 s54, s54, s52
  buffer_load_dwordx4 v[88:91], v57, s[16:19], s54 offen
  s_add_u32 s54, s54, 8192
  buffer_load_dwordx4 v[92:95], v57, s[16:19], s54 offen
  s_mul_i32 s54, s53, 57344
  s_add_u32 s54, s54, s52
  buffer_load_dwordx4 v[124:127], v57, s[24:27], s54 offen
  s_add_u32 s54, s54, 8192
  buffer_load_dwordx4 v[128:131], v57, s[24:27], s54 offen
  s_add_u32 s54, s54, 8192
  buffer_load_dwordx4 v[132:135], v57, s[24:27], s54 offen
  s_add_u32 s54, s54, 8192
  buffer_load_dwordx4 v[136:139], v57, s[24:27], s54 offen
  s_add_u32 s54, s54, 8192
  buffer_load_dwordx4 v[140:143], v57, s[24:27], s54 offen
  s_add_u32 s54, s54, 8192
  buffer_load_dwordx4 v[144:147], v57, s[24:27], s54 offen
  s_add_u32 s54, s54, 8192
  buffer_load_dwordx4 v[148:151], v57, s[24:27], s54 offen
  s_mul_i32 s53, s2, 7
  s_add_u32 s54, s53, 0
  s_lshr_b32 s55, s54, 7
  s_lshl_b32 s55, s55, 8
  s_and_b32 s54, s54, 127
  s_mul_i32 s54, s54, 14336
  s_add_u32 s54, s54, s55
  buffer_load_dwordx4 v[96:99], v58, s[20:23], s54 offen
  s_add_u32 s54, s53, 1
  s_lshr_b32 s55, s54, 7
  s_lshl_b32 s55, s55, 8
  s_and_b32 s54, s54, 127
  s_mul_i32 s54, s54, 14336
  s_add_u32 s54, s54, s55
  buffer_load_dwordx4 v[100:103], v58, s[20:23], s54 offen
  s_add_u32 s54, s53, 2
  s_lshr_b32 s55, s54, 7
  s_lshl_b32 s55, s55, 8
  s_and_b32 s54, s54, 127
  s_mul_i32 s54, s54, 14336
  s_add_u32 s54, s54, s55
  buffer_load_dwordx4 v[104:107], v58, s[20:23], s54 offen
  s_add_u32 s54, s53, 3
  s_lshr_b32 s55, s54, 7
  s_lshl_b32 s55, s55, 8
  s_and_b32 s54, s54, 127
  s_mul_i32 s54, s54, 14336
  s_add_u32 s54, s54, s55
  buffer_load_dwordx4 v[108:111], v58, s[20:23], s54 offen
  s_add_u32 s54, s53, 4
  s_lshr_b32 s55, s54, 7
  s_lshl_b32 s55, s55, 8
  s_and_b32 s54, s54, 127
  s_mul_i32 s54, s54, 14336
  s_add_u32 s54, s54, s55
  buffer_load_dwordx4 v[112:115], v58, s[20:23], s54 offen
  s_add_u32 s54, s53, 5
  s_lshr_b32 s55, s54, 7
  s_lshl_b32 s55, s55, 8
  s_and_b32 s54, s54, 127
  s_mul_i32 s54, s54, 14336
  s_add_u32 s54, s54, s55
  buffer_load_dwordx4 v[116:119], v58, s[20:23], s54 offen
  s_add_u32 s54, s53, 6
  s_lshr_b32 s55, s54, 7
  s_lshl_b32 s55, s55, 8
  s_and_b32 s54, s54, 127
  s_mul_i32 s54, s54, 14336
  s_add_u32 s54, s54, s55
  buffer_load_dwordx4 v[120:123], v58, s[20:23], s54 offen
L_noreg_17:
  s_cmp_eq_u32 s46, 7
  s_cbranch_scc1 L_plain_20
  v_lshrrev_b32 v4, 5, v0
  v_lshlrev_b32 v4, 2, v4
  v_bfe_u32 v6, v0, 2, 2
  v_add_u32 v4, v4, v6
  v_bfe_u32 v5, v0, 4, 1
  v_lshlrev_b32 v5, 5, v5
  v_and_b32 v6, 3, v0
  v_lshlrev_b32 v6, 3, v6
  v_add_u32 v5, v5, v6
  s_sub_u32 s52, s46, 4
  v_lshl_add_u32 v4, v4, 6, v5
  s_lshl_b32 s53, s52, 15
  v_add_u32 v4, s53, v4
  v_mov_b32 v8, 0x3f803f80
  v_mov_b32 v9, 0x3f803f80
  v_mov_b32 v10, 0x3f803f80
  v_mov_b32 v11, 0x3f803f80
  s_cmp_eq_u32 s46, 4
  s_cbranch_scc1 L_skipwait_22
  s_waitcnt vmcnt(8)
L_skipwait_22:
  s_barrier
  s_cmp_lt_u32 s46, 5
  s_cbranch_scc1 L_skip_23
  v_lshrrev_b32 v2, 2, v0
  v_mul_u32_u24 v2, 3072, v2
  v_and_b32 v3, 3, v0
  v_lshl_add_u32 v2, v3, 4, v2
  s_sub_u32 s52, s46, 5
  s_lshl_b32 s53, s52, 10
  s_lshl_b32 s54, s45, 6
  s_add_u32 s53, s53, s54
  s_add_u32 s53, s53, 786432
  s_lshl_b32 s52, s52, 15
  s_add_u32 m0, s52, 16384
  s_mov_b32 s91, 8
L_dma_24:
  buffer_load_dwordx4 v2, s[12:15], s53 offen lds
  s_add_u32 m0, m0, 1024
  s_add_u32 s53, s53, 49152
  s_sub_u32 s91, s91, 1
  s_cmp_lg_u32 s91, 0
  s_cbranch_scc1 L_dma_24
L_skip_23:
  ds_read_b64_tr_b16 v[16:17], v4 offset:0
  ds_read_b64_tr_b16 v[18:19], v4 offset:512
  ds_read_b64_tr_b16 v[20:21], v4 offset:1024
  ds_read_b64_tr_b16 v[22:23], v4 offset:1536
  ds_read_b64_tr_b16 v[24:25], v4 offset:2048
  ds_read_b64_tr_b16 v[26:27], v4 offset:2560
  ds_read_b64_tr_b16 v[28:29], v4 offset:3072
  ds_read_b64_tr_b16 v[30:31], v4 offset:3584
  ds_read_b64_tr_b16 v[32:33], v4 offset:4096
  ds_read_b64_tr_b16 v[34:35], v4 offset:4608
  ds_read_b64_tr_b16 v[36:37], v4 offset:5120
  ds_read_b64_tr_b16 v[38:39], v4 offset:5632
  ds_read_b64_tr_b16 v[40:41], v4 offset:6144
  ds_read_b64_tr_b16 v[42:43], v4 offset:6656
  ds_read_b64_tr_b16 v[44:45], v4 offset:7168
  ds_read_b64_tr_b16 v[46:47], v4 offset:7680
  v_add_u32 v4, 8192, v4
  s_waitcnt lgkmcnt(14)
  v_mfma_f32_32x32x16_bf16 v[240:255], v[16:19], v[8:11], 0
  s_waitcnt lgkmcnt(12)
  v_mfma_f32_32x32x16_bf16 v[240:255], v[20:23], v[8:11], v[240:255]
  s_waitcnt lgkmcnt(10)
  v_mfma_f32_32x32x16_bf16 v[240:255], v[24:27], v[8:11], v[240:255]
  s_waitcnt lgkmcnt(8)
  v_mfma_f32_32x32x16_bf16 v[240:255], v[28:31], v[8:11], v[240:255]
  s_waitcnt lgkmcnt(6)
  v_mfma_f32_32x32x16_bf16 v[240:255], v[32:35], v[8:11], v[240:255]
  s_waitcnt lgkmcnt(4)
  v_mfma_f32_32x32x16_bf16 v[240:255], v[36:39], v[8:11], v[240:255]
  s_waitcnt lgkmcnt(2)
  v_mfma_f32_32x32x16_bf16 v[240:255], v[40:43], v[8:11], v[240:255]
  s_waitcnt lgkmcnt(0)
  v_mfma_f32_32x32x16_bf16 v[240:255], v[44:47], v[8:11], v[240:255]
  s_cmp_lg_u32 s46, 4
  s_cbranch_scc1 L_w4o_25
  s_waitcnt vmcnt(0)
  s_mul_i32 s52, s2, 6144
  s_add_u32 s52, s52, 25165824
  buffer_store_dwordx4 v[64:67], v1, s[8:11], s52 offen offset:0 sc1
  buffer_store_dwordx4 v[68:71], v1, s[8:11], s52 offen offset:1024 sc1
  buffer_store_dwordx4 v[72:75], v1, s[8:11], s52 offen offset:2048 sc1
  buffer_store_dwordx4 v[76:79], v1, s[8:11], s52 offen offset:3072 sc1
  s_add_u32 s52, s52, 4096
  buffer_store_dwordx4 v[80:83], v1, s[8:11], s52 offen offset:0 sc1
  buffer_store_dwordx4 v[84:87], v1, s[8:11], s52 offen offset:1024 sc1
  s_mul_i32 s52, s2, 2048
  s_add_u32 s52, s52, 27262976
  buffer_store_dwordx4 v[88:91], v1, s[8:11], s52 offen offset:0 sc1
  buffer_store_dwordx4 v[92:95], v1, s[8:11], s52 offen offset:1024 sc1
  s_mul_i32 s52, s2, 7168
  s_add_u32 s52, s52, 28311552
  buffer_store_dwordx4 v[96:99], v1, s[8:11], s52 offen offset:0 sc1
  buffer_store_dwordx4 v[100:103], v1, s[8:11], s52 offen offset:1024 sc1
  buffer_store_dwordx4 v[104:107], v1, s[8:11], s52 offen offset:2048 sc1
  buffer_store_dwordx4 v[108:111], v1, s[8:11], s52 offen offset:3072 sc1
  s_add_u32 s52, s52, 4096
  buffer_store_dwordx4 v[112:115], v1, s[8:11], s52 offen offset:0 sc1
  buffer_store_dwordx4 v[116:119], v1, s[8:11], s52 offen offset:1024 sc1
  buffer_store_dwordx4 v[120:123], v1, s[8:11], s52 offen offset:2048 sc1
  s_mul_i32 s52, s2, 7168
  s_add_u32 s52, s52, 30408704
  buffer_store_dwordx4 v[124:127], v1, s[8:11], s52 offen offset:0 sc1
  buffer_store_dwordx4 v[128:131], v1, s[8:11], s52 offen offset:1024 sc1
  buffer_store_dwordx4 v[132:135], v1, s[8:11], s52 offen offset:2048 sc1
  buffer_store_dwordx4 v[136:139], v1, s[8:11], s52 offen offset:3072 sc1
  s_add_u32 s52, s52, 4096
  buffer_store_dwordx4 v[140:143], v1, s[8:11], s52 offen offset:0 sc1
  buffer_store_dwordx4 v[144:147], v1, s[8:11], s52 offen offset:1024 sc1
  buffer_store_dwordx4 v[148:151], v1, s[8:11], s52 offen offset:2048 sc1
L_w4o_25:
  s_cmp_eq_u32 s46, 4
  s_cbranch_scc1 L_skipwait_26
  s_waitcnt vmcnt(8)
L_skipwait_26:
  s_barrier
  s_cmp_lt_u32 s46, 5
  s_cbranch_scc1 L_skip_27
  v_lshrrev_b32 v2, 2, v0
  v_mul_u32_u24 v2, 3072, v2
  v_and_b32 v3, 3, v0
  v_lshl_add_u32 v2, v3, 4, v2
  s_sub_u32 s52, s46, 5
  s_lshl_b32 s53, s52, 10
  s_lshl_b32 s54, s45, 6
  s_add_u32 s53, s53, s54
  s_add_u32 s53, s53, 1179648
  s_lshl_b32 s52, s52, 15
  s_add_u32 m0, s52, 24576
  s_mov_b32 s91, 8
L_dma_28:
  buffer_load_dwordx4 v2, s[12:15], s53 offen lds
  s_add_u32 m0, m0, 1024
  s_add_u32 s53, s53, 49152
  s_sub_u32 s91, s91, 1
  s_cmp_lg_u32 s91, 0
  s_cbranch_scc1 L_dma_28
L_skip_27:
  ds_read_b64_tr_b16 v[16:17], v4 offset:0
  ds_read_b64_tr_b16 v[18:19], v4 offset:512
  ds_read_b64_tr_b16 v[20:21], v4 offset:1024
  ds_read_b64_tr_b16 v[22:23], v4 offset:1536
  ds_read_b64_tr_b16 v[24:25], v4 offset:2048
  ds_read_b64_tr_b16 v[26:27], v4 offset:2560
  ds_read_b64_tr_b16 v[28:29], v4 offset:3072
  ds_read_b64_tr_b16 v[30:31], v4 offset:3584
  ds_read_b64_tr_b16 v[32:33], v4 offset:4096
  ds_read_b64_tr_b16 v[34:35], v4 offset:4608
  ds_read_b64_tr_b16 v[36:37], v4 offset:5120
  ds_read_b64_tr_b16 v[38:39], v4 offset:5632
  ds_read_b64_tr_b16 v[40:41], v4 offset:6144
  ds_read_b64_tr_b16 v[42:43], v4 offset:6656
  ds_read_b64_tr_b16 v[44:45], v4 offset:7168
  ds_read_b64_tr_b16 v[46:47], v4 offset:7680
  v_add_u32 v4, 8192, v4
  s_waitcnt lgkmcnt(14)
  v_mfma_f32_32x32x16_bf16 v[240:255], v[16:19], v[8:11], v[240:255]
  s_waitcnt lgkmcnt(12)
  v_mfma_f32_32x32x16_bf16 v[240:255], v[20:23], v[8:11], v[240:255]
  s_waitcnt lgkmcnt(10)
  v_mfma_f32_32x32x16_bf16 v[240:255], v[24:27], v[8:11], v[240:255]
  s_waitcnt lgkmcnt(8)
  v_mfma_f32_32x32x16_bf16 v[240:255], v[28:31], v[8:11], v[240:255]
  s_waitcnt lgkmcnt(6)
  v_mfma_f32_32x32x16_bf16 v[240:255], v[32:35], v[8:11], v[240:255]
  s_waitcnt lgkmcnt(4)
  v_mfma_f32_32x32x16_bf16 v[240:255], v[36:39], v[8:11], v[240:255]
  s_waitcnt lgkmcnt(2)
  v_mfma_f32_32x32x16_bf16 v[240:255], v[40:43], v[8:11], v[240:255]
  s_waitcnt lgkmcnt(0)
  v_mfma_f32_32x32x16_bf16 v[240:255], v[44:47], v[8:11], v[240:255]
  s_cmp_eq_u32 s46, 4
  s_cbranch_scc1 L_skipwait_29
  s_waitcnt vmcnt(8)
L_skipwait_29:
  s_barrier
  ds_read_b64_tr_b16 v[16:17], v4 offset:0
  ds_read_b64_tr_b16 v[18:19], v4 offset:512
  ds_read_b64_tr_b16 v[20:21], v4 offset:1024
  ds_read_b64_tr_b16 v[22:23], v4 offset:1536
  ds_read_b64_tr_b16 v[24:25], v4 offset:2048
  ds_read_b64_tr_b16 v[26:27], v4 offset:2560
  ds_read_b64_tr_b16 v[28:29], v4 offset:3072
  ds_read_b64_tr_b16 v[30:31], v4 offset:3584
  ds_read_b64_tr_b16 v[32:33], v4 offset:4096
  ds_read_b64_tr_b16 v[34:35], v4 offset:4608
  ds_read_b64_tr_b16 v[36:37], v4 offset:5120
  ds_read_b64_tr_b16 v[38:39], v4 offset:5632
  ds_read_b64_tr_b16 v[40:41], v4 offset:6144
  ds_read_b64_tr_b16 v[42:43], v4 offset:6656
  ds_read_b64_tr_b16 v[44:45], v4 offset:7168
  ds_read_b64_tr_b16 v[46:47], v4 offset:7680
  v_add_u32 v4, 8192, v4
  s_waitcnt lgkmcnt(14)
  v_mfma_f32_32x32x16_bf16 v[240:255], v[16:19], v[8:11], v[240:255]
  s_waitcnt lgkmcnt(12)
  v_mfma_f32_32x32x16_bf16 v[240:255], v[20:23], v[8:11], v[240:255]
  s_waitcnt lgkmcnt(10)
  v_mfma_f32_32x32x16_bf16 v[240:255], v[24:27], v[8:11], v[240:255]
  s_waitcnt lgkmcnt(8)
  v_mfma_f32_32x32x16_bf16 v[240:255], v[28:31], v[8:11], v[240:255]
  s_waitcnt lgkmcnt(6)
  v_mfma_f32_32x32x16_bf16 v[240:255], v[32:35], v[8:11], v[240:255]
  s_waitcnt lgkmcnt(4)
  v_mfma_f32_32x32x16_bf16 v[240:255], v[36:39], v[8:11], v[240:255]
  s_waitcnt lgkmcnt(2)
  v_mfma_f32_32x32x16_bf16 v[240:255], v[40:43], v[8:11], v[240:255]
  s_waitcnt lgkmcnt(0)
  v_mfma_f32_32x32x16_bf16 v[240:255], v[44:47], v[8:11], v[240:255]
  s_cmp_lg_u32 s46, 4
  s_cbranch_scc1 L_w4o_30
  v_mov_b32 v54, 0
  s_mov_b32 s91, 262144
L_npoll_31:
  buffer_load_dword v55, v54, s[36:39], 0 offen sc1
  s_waitcnt vmcnt(0)
  v_readfirstlane_b32 s95, v55
  s_cmp_lg_u32 s95, 0
  s_cbranch_scc1 L_ndone_32
  s_sleep 2
  s_sub_u32 s91, s91, 1
  s_cbranch_scc0 L_npoll_31
  s_mov_b32 s51, 1
L_ndone_32:
  s_add_u32 s52, s92, 1
  v_mov_b32 v56, s95
  v_mov_b32 v57, s52
  v_mov_b32 v58, 0
  s_lshl_b32 s53, s44, 4
  s_add_u32 s53, s53, s45
  s_lshl_b32 s53, s53, 3
  s_add_u32 s53, s53, 98304
  s_mov_b64 exec, 1
  buffer_store_dwordx2 v[56:57], v58, s[8:11], s53 offen sc1
  s_mov_b64 exec, -1
L_w4o_30:
  s_cmp_eq_u32 s46, 4
  s_cbranch_scc1 L_skipwait_33
  s_waitcnt vmcnt(0)
L_skipwait_33:
  s_barrier
  ds_read_b64_tr_b16 v[16:17], v4 offset:0
  ds_read_b64_tr_b16 v[18:19], v4 offset:512
  ds_read_b64_tr_b16 v[20:21], v4 offset:1024
  ds_read_b64_tr_b16 v[22:23], v4 offset:1536
  ds_read_b64_tr_b16 v[24:25], v4 offset:2048
  ds_read_b64_tr_b16 v[26:27], v4 offset:2560
  ds_read_b64_tr_b16 v[28:29], v4 offset:3072
  ds_read_b64_tr_b16 v[30:31], v4 offset:3584
  ds_read_b64_tr_b16 v[32:33], v4 offset:4096
  ds_read_b64_tr_b16 v[34:35], v4 offset:4608
  ds_read_b64_tr_b16 v[36:37], v4 offset:5120
  ds_read_b64_tr_b16 v[38:39], v4 offset:5632
  ds_read_b64_tr_b16 v[40:41], v4 offset:6144
  ds_read_b64_tr_b16 v[42:43], v4 offset:6656
  ds_read_b64_tr_b16 v[44:45], v4 offset:7168
  ds_read_b64_tr_b16 v[46:47], v4 offset:7680
  v_add_u32 v4, 8192, v4
  s_waitcnt lgkmcnt(14)
  v_mfma_f32_32x32x16_bf16 v[240:255], v[16:19], v[8:11], v[240:255]
  s_waitcnt lgkmcnt(12)
  v_mfma_f32_32x32x16_bf16 v[240:255], v[20:23], v[8:11], v[240:255]
  s_waitcnt lgkmcnt(10)
  v_mfma_f32_32x32x16_bf16 v[240:255], v[24:27], v[8:11], v[240:255]
  s_waitcnt lgkmcnt(8)
  v_mfma_f32_32x32x16_bf16 v[240:255], v[28:31], v[8:11], v[240:255]
  s_waitcnt lgkmcnt(6)
  v_mfma_f32_32x32x16_bf16 v[240:255], v[32:35], v[8:11], v[240:255]
  s_waitcnt lgkmcnt(4)
  v_mfma_f32_32x32x16_bf16 v[240:255], v[36:39], v[8:11], v[240:255]
  s_waitcnt lgkmcnt(2)
  v_mfma_f32_32x32x16_bf16 v[240:255], v[40:43], v[8:11], v[240:255]
  s_waitcnt lgkmcnt(0)
  v_mfma_f32_32x32x16_bf16 v[240:255], v[44:47], v[8:11], v[240:255]
  s_nop 13
  s_sub_u32 s52, s46, 4
  s_lshl_b32 s53, s52, 7
  s_add_u32 s53, s53, 161792
  v_lshrrev_b32 v10, 5, v0
  v_lshl_add_u32 v10, v10, 4, s53
  s_mov_b32 s54, 1
  s_mov_b32 s55, 1
  s_mov_b64 exec, s[54:55]
  ds_write_b128 v10, v[240:243] offset:0
  ds_write_b128 v10, v[244:247] offset:32
  ds_write_b128 v10, v[248:251] offset:64
  ds_write_b128 v10, v[252:255] offset:96
  s_mov_b64 exec, -1
  s_waitcnt lgkmcnt(0)
  s_branch L_c1_21
L_plain_20:
  s_cmp_eq_u32 s46, 4
  s_cbranch_scc1 L_skipwait_34
  s_waitcnt vmcnt(8)
L_skipwait_34:
  s_barrier
  s_cmp_lt_u32 s46, 5
  s_cbranch_scc1 L_skip_35
  v_lshrrev_b32 v2, 2, v0
  v_mul_u32_u24 v2, 3072, v2
  v_and_b32 v3, 3, v0
  v_lshl_add_u32 v2, v3, 4, v2
  s_sub_u32 s52, s46, 5
  s_lshl_b32 s53, s52, 10
  s_lshl_b32 s54, s45, 6
  s_add_u32 s53, s53, s54
  s_add_u32 s53, s53, 786432
  s_lshl_b32 s52, s52, 15
  s_add_u32 m0, s52, 16384
  s_mov_b32 s91, 8
L_dma_36:
  buffer_load_dwordx4 v2, s[12:15], s53 offen lds
  s_add_u32 m0, m0, 1024
  s_add_u32 s53, s53, 49152
  s_sub_u32 s91, s91, 1
  s_cmp_lg_u32 s91, 0
  s_cbranch_scc1 L_dma_36
L_skip_35:
  s_cmp_eq_u32 s46, 4
  s_cbranch_scc1 L_skipwait_37
  s_waitcnt vmcnt(8)
L_skipwait_37:
  s_barrier
  s_cmp_lt_u32 s46, 5
  s_cbranch_scc1 L_skip_38
  v_lshrrev_b32 v2, 2, v0
  v_mul_u32_u24 v2, 3072, v2
  v_and_b32 v3, 3, v0
  v_lshl_add_u32 v2, v3, 4, v2
  s_sub_u32 s52, s46, 5
  s_lshl_b32 s53, s52, 10
  s_lshl_b32 s54, s45, 6
  s_add_u32 s53, s53, s54
  s_add_u32 s53, s53, 1179648
  s_lshl_b32 s52, s52, 15
  s_add_u32 m0, s52, 24576
  s_mov_b32 s91, 8
L_dma_39:
  buffer_load_dwordx4 v2, s[12:15], s53 offen lds
  s_add_u32 m0, m0, 1024
  s_add_u32 s53, s53, 49152
  s_sub_u32 s91, s91, 1
  s_cmp_lg_u32 s91, 0
  s_cbranch_scc1 L_dma_39
L_skip_38:
  s_cmp_eq_u32 s46, 4
  s_cbranch_scc1 L_skipwait_40
  s_waitcnt vmcnt(8)
L_skipwait_40:
  s_barrier
  s_cmp_eq_u32 s46, 4
  s_cbranch_scc1 L_skipwait_41
  s_waitcnt vmcnt(0)
L_skipwait_41:
  s_barrier
L_c1_21:
  s_barrier
  s_barrier
  s_cmp_lg_u32 s46, 4
  s_cbranch_scc1 L_noreg2_42
  s_mov_b32 s90, 1
  v_lshlrev_b32 v4, 3, v0
  s_mov_b32 s52, 98304
  s_mov_b32 s91, 262144
  s_cmp_eq_u32 s51, 0
  s_cbranch_scc0 L_pdone_44
L_poll_43:
  buffer_load_dwordx2 v[6:7], v4, s[8:11], s52 offen sc1
  s_waitcnt vmcnt(0)
  v_subrev_u32 v8, s90, v7
  v_cmp_ne_u32 vcc, s95, v6
  v_cmp_lt_u32 s[62:63], 31, v8
  s_or_b64 vcc, vcc, s[62:63]
  s_cbranch_vccz L_pdone_44
  s_sleep 16
  s_sub_u32 s91, s91, 1
  s_cbranch_scc0 L_poll_43
  s_mov_b32 s51, 1
L_pdone_44:
  s_mov_b32 s52, 98816
  s_mov_b32 s91, 262144
  s_cmp_eq_u32 s51, 0
  s_cbranch_scc0 L_pdone_46
L_poll_45:
  buffer_load_dwordx2 v[6:7], v4, s[8:11], s52 offen sc1
  s_waitcnt vmcnt(0)
  v_subrev_u32 v8, s90, v7
  v_cmp_ne_u32 vcc, s95, v6
  v_cmp_lt_u32 s[62:63], 31, v8
  s_or_b64 vcc, vcc, s[62:63]
  s_cbranch_vccz L_pdone_46
  s_sleep 16
  s_sub_u32 s91, s91, 1
  s_cbranch_scc0 L_poll_45
  s_mov_b32 s51, 1
L_pdone_46:
  s_mov_b32 s52, 99328
  s_mov_b32 s91, 262144
  s_cmp_eq_u32 s51, 0
  s_cbranch_scc0 L_pdone_48
L_poll_47:
  buffer_load_dwordx2 v[6:7], v4, s[8:11], s52 offen sc1
  s_waitcnt vmcnt(0)
  v_subrev_u32 v8, s90, v7
  v_cmp_ne_u32 vcc, s95, v6
  v_cmp_lt_u32 s[62:63], 31, v8
  s_or_b64 vcc, vcc, s[62:63]
  s_cbranch_vccz L_pdone_48
  s_sleep 16
  s_sub_u32 s91, s91, 1
  s_cbranch_scc0 L_poll_47
  s_mov_b32 s51, 1
L_pdone_48:
  s_mov_b32 s52, 99840
  s_mov_b32 s91, 262144
  s_cmp_eq_u32 s51, 0
  s_cbranch_scc0 L_pdone_50
L_poll_49:
  buffer_load_dwordx2 v[6:7], v4, s[8:11], s52 offen sc1
  s_waitcnt vmcnt(0)
  v_subrev_u32 v8, s90, v7
  v_cmp_ne_u32 vcc, s95, v6
  v_cmp_lt_u32 s[62:63], 31, v8
  s_or_b64 vcc, vcc, s[62:63]
  s_cbranch_vccz L_pdone_50
  s_sleep 16
  s_sub_u32 s91, s91, 1
  s_cbranch_scc0 L_poll_49
  s_mov_b32 s51, 1
L_pdone_50:
  v_and_b32 v4, 15, v0
  v_lshlrev_b32 v4, 3, v4
  s_lshl_b32 s52, s44, 7
  s_add_u32 s52, s52, 98304
  v_mov_b32 v7, 0
  s_mov_b32 s91, 262144
  s_cmp_eq_u32 s51, 0
  s_cbranch_scc0 L_pdone_52
L_poll_51:
  buffer_load_dwordx2 v[6:7], v4, s[8:11], s52 offen sc1
  s_waitcnt vmcnt(0)
  v_subrev_u32 v8, s90, v7
  v_cmp_ne_u32 vcc, s95, v6
  v_cmp_lt_u32 s[62:63], 31, v8
  s_or_b64 vcc, vcc, s[62:63]
  s_cbranch_vccz L_pdone_52
  s_sleep 2
  s_sub_u32 s91, s91, 1
  s_cbranch_scc0 L_poll_51
  s_mov_b32 s51, 1
L_pdone_52:
  s_add_u32 s52, s92, 1
  v_cmp_ne_u32 vcc, s52, v7
  s_cmp_eq_u64 vcc, 0
  s_cselect_b32 s47, 1, 0
  v_mov_b32 v5, s47
  v_mov_b32 v4, 163584
  ds_write_b32 v4, v5
  s_waitcnt lgkmcnt(0)
L_noreg2_42:
  s_barrier
  s_branch L_p2
L_p1_helper_l1:
  s_waitcnt vmcnt(8)
  s_barrier
  s_cmp_lt_u32 s46, 5
  s_cbranch_scc1 L_skip_55
  s_sub_u32 s52, s46, 5
  s_lshl_b32 s52, s52, 15
  s_mul_i32 s53, s45, 98304
  s_add_u32 s53, s53, s52
  s_add_u32 s53, s53, 25182208
  s_add_u32 m0, s52, 16384
  s_mov_b32 s91, 8
L_dma_56:
  buffer_load_dwordx4 v1, s[8:11], s53 offen sc1 lds
  s_add_u32 m0, m0, 1024
  s_add_u32 s53, s53, 1024
  s_sub_u32 s91, s91, 1
  s_cmp_lg_u32 s91, 0
  s_cbranch_scc1 L_dma_56
L_skip_55:
  s_waitcnt vmcnt(8)
  s_barrier
  s_cmp_lt_u32 s46, 5
  s_cbranch_scc1 L_skip_57
  s_sub_u32 s52, s46, 5
  s_lshl_b32 s52, s52, 15
  s_mul_i32 s53, s45, 98304
  s_add_u32 s53, s53, s52
  s_add_u32 s53, s53, 25190400
  s_add_u32 m0, s52, 24576
  s_mov_b32 s91, 8
L_dma_58:
  buffer_load_dwordx4 v1, s[8:11], s53 offen sc1 lds
  s_add_u32 m0, m0, 1024
  s_add_u32 s53, s53, 1024
  s_sub_u32 s91, s91, 1
  s_cmp_lg_u32 s91, 0
  s_cbranch_scc1 L_dma_58
L_skip_57:
  s_waitcnt vmcnt(8)
  s_barrier
  s_waitcnt vmcnt(0)
  s_barrier
  s_barrier
  s_barrier
L_p2:
  v_mov_b32 v160, 163584
  ds_read_b32 v156, v160
  s_and_b32 s52, s46, 3
  s_lshr_b32 s53, s46, 2
  s_lshl_b32 s93, s44, 2
  s_add_u32 s93, s93, s52
  s_add_u32 s93, s93, 1
  s_min_u32 s93, s93, 9
  s_lshl_b32 s54, s52, 11
  s_lshl_b32 s55, s53, 10
  s_add_u32 s56, s54, s55
  v_add_u32 v158, s56, v1
  s_lshl_b32 s55, s53, 8
  s_add_u32 s56, s54, s55
  v_add_u32 v159, s56, v1
  ds_read_b128 v[4:7], v158 offset:49152
  ds_read_b128 v[8:11], v158 offset:16384
  ds_read_b128 v[12:15], v158 offset:14336
  ds_read_b128 v[16:19], v158 offset:12288
  ds_read_b128 v[20:23], v158 offset:10240
  ds_read_b128 v[24:27], v158 offset:8192
  ds_read_b128 v[28:31], v158 offset:6144
  ds_read_b128 v[32:35], v158 offset:4096
  ds_read_b128 v[36:39], v158 offset:2048
  ds_read_b128 v[40:43], v158 offset:0
  v_add_u32 v160, 151552, v1
  ds_read_b128 v[148:151], v160 offset:8192
  ds_read_b128 v[152:155], v160 offset:9216
  s_and_b32 s57, s45, 7
  s_lshl_b32 s57, s57, 16
  s_lshl_b32 s58, s46, 13
  s_add_u32 s57, s57, s58
  s_add_u32 s57, s57, 27262976
  s_add_u32 m0, s58, 65536
  s_min_u32 s60, s45, 13
  s_lshl_b32 s60, s60, 17
  s_lshl_b32 s58, s46, 14
  s_add_u32 s60, s60, s58
  s_add_u32 s60, s60, 28311552
  v_mov_b32 v44, 0x3f803f80
  v_mov_b32 v45, 0x3f803f80
  v_mov_b32 v46, 0x3f803f80
  v_mov_b32 v47, 0x3f803f80
  v_mov_b32 v48, 0x3f803f80
  v_mov_b32 v49, 0x3f803f80
  v_mov_b32 v50, 0x3f803f80
  v_mov_b32 v51, 0x3f803f80
  v_mov_b32 v52, 0x3f803f80
  v_mov_b32 v53, 0x3f803f80
  v_mov_b32 v54, 0x3f803f80
  v_mov_b32 v55, 0x3f803f80
  v_mov_b32 v56, 0x3f803f80
  v_mov_b32 v57, 0x3f803f80
  v_mov_b32 v58, 0x3f803f80
  v_mov_b32 v59, 0x3f803f80
  s_waitcnt lgkmcnt(0)
  v_readfirstlane_b32 s47, v156
  s_cmp_eq_u32 s93, 9
  s_cselect_b64 vcc, -1, 0
  s_cbranch_vccnz L_fastgo_62
  buffer_load_dwordx4 v1, s[8:11], s57 offen sc1 lds
  s_add_u32 m0, m0, 1024
  s_add_u32 s57, s57, 1024
  buffer_load_dwordx4 v1, s[8:11], s57 offen sc1 lds
  s_add_u32 m0, m0, 1024
  s_add_u32 s57, s57, 1024
  buffer_load_dwordx4 v1, s[8:11], s57 offen sc1 lds
  s_add_u32 m0, m0, 1024
  s_add_u32 s57, s57, 1024
  buffer_load_dwordx4 v1, s[8:11], s57 offen sc1 lds
  s_add_u32 m0, m0, 1024
  s_add_u32 s57, s57, 1024
  buffer_load_dwordx4 v1, s[8:11], s57 offen sc1 lds
  s_add_u32 m0, m0, 1024
  s_add_u32 s57, s57, 1024
  buffer_load_dwordx4 v1, s[8:11], s57 offen sc1 lds
  s_add_u32 m0, m0, 1024
  s_add_u32 s57, s57, 1024
  buffer_load_dwordx4 v1, s[8:11], s57 offen sc1 lds
  s_add_u32 m0, m0, 1024
  s_add_u32 s57, s57, 1024
  buffer_load_dwordx4 v1, s[8:11], s57 offen sc1 lds
  s_add_u32 m0, m0, 1024
  s_add_u32 s57, s57, 1024
  buffer_load_dwordx4 v[180:183], v1, s[8:11], s60 offen offset:0 sc1
  buffer_load_dwordx4 v[184:187], v1, s[8:11], s60 offen offset:1024 sc1
  buffer_load_dwordx4 v[188:191], v1, s[8:11], s60 offen offset:2048 sc1
  buffer_load_dwordx4 v[192:195], v1, s[8:11], s60 offen offset:3072 sc1
  s_add_u32 s60, s60, 4096
  buffer_load_dwordx4 v[196:199], v1, s[8:11], s60 offen offset:0 sc1
  buffer_load_dwordx4 v[200:203], v1, s[8:11], s60 offen offset:1024 sc1
  buffer_load_dwordx4 v[204:207], v1, s[8:11], s60 offen offset:2048 sc1
  buffer_load_dwordx4 v[208:211], v1, s[8:11], s60 offen offset:3072 sc1
  s_add_u32 s60, s60, 4096
  buffer_load_dwordx4 v[212:215], v1, s[8:11], s60 offen offset:0 sc1
  buffer_load_dwordx4 v[216:219], v1, s[8:11], s60 offen offset:1024 sc1
  buffer_load_dwordx4 v[220:223], v1, s[8:11], s60 offen offset:2048 sc1
  buffer_load_dwordx4 v[224:227], v1, s[8:11], s60 offen offset:3072 sc1
  s_add_u32 s60, s60, 4096
  buffer_load_dwordx4 v[228:231], v1, s[8:11], s60 offen offset:0 sc1
  buffer_load_dwordx4 v[232:235], v1, s[8:11], s60 offen offset:1024 sc1
  buffer_load_dwordx4 v[236:239], v1, s[8:11], s60 offen offset:2048 sc1
  buffer_load_dwordx4 v[240:243], v1, s[8:11], s60 offen offset:3072 sc1
L_fastgo_62:
  v_mfma_f32_32x32x16_bf16 v[60:75], v[8:11], v[4:7], 0
  v_mfma_f32_32x32x16_bf16 v[76:91], v[12:15], v[4:7], 0
  s_mov_b64 exec, s[86:87]
  ds_read_b128 v[44:47], v159 offset:40960
  ds_read_b128 v[48:51], v159 offset:41984
  s_mov_b64 exec, -1
  s_cbranch_vccz L_bgs_64
  buffer_load_dwordx4 v1, s[8:11], s57 offen sc1 lds
  s_add_u32 m0, m0, 1024
  s_add_u32 s57, s57, 1024
L_bgs_64:
  s_cbranch_vccz L_bgs_65
  buffer_load_dwordx4 v1, s[8:11], s57 offen sc1 lds
  s_add_u32 m0, m0, 1024
  s_add_u32 s57, s57, 1024
L_bgs_65:
  s_cbranch_vccz L_bgs_66
  buffer_load_dwordx4 v1, s[8:11], s57 offen sc1 lds
  s_add_u32 m0, m0, 1024
  s_add_u32 s57, s57, 1024
L_bgs_66:
  s_nop 9
  v_mfma_f32_32x32x16_bf16 v[92:107], v[16:19], v[4:7], 0
  s_mov_b64 exec, s[86:87]
  ds_read_b128 v[52:55], v159 offset:38912
  ds_read_b128 v[56:59], v159 offset:39936
  s_mov_b64 exec, -1
  s_cbranch_vccz L_bgs_67
  buffer_load_dwordx4 v1, s[8:11], s57 offen sc1 lds
  s_add_u32 m0, m0, 1024
  s_add_u32 s57, s57, 1024
L_bgs_67:
  v_exp_f32 v60, v60
  v_exp_f32 v61, v61
  v_exp_f32 v62, v62
  v_exp_f32 v63, v63
  v_exp_f32 v64, v64
  v_exp_f32 v65, v65
  v_exp_f32 v66, v66
  v_exp_f32 v67, v67
  v_cvt_pk_bf16_f32 v108, v60, v61
  v_cvt_pk_bf16_f32 v109, v62, v63
  v_cvt_pk_bf16_f32 v110, v64, v65
  v_cvt_pk_bf16_f32 v111, v66, v67
  v_and_b32 v108, v108, v148
  v_and_b32 v109, v109, v149
  v_and_b32 v110, v110, v150
  v_and_b32 v111, v111, v151
  v_exp_f32 v68, v68
  v_exp_f32 v69, v69
  v_exp_f32 v70, v70
  v_exp_f32 v71, v71
  v_exp_f32 v72, v72
  v_exp_f32 v73, v73
  v_exp_f32 v74, v74
  v_exp_f32 v75, v75
  s_cbranch_vccz L_bgs_68
  buffer_load_dwordx4 v1, s[8:11], s57 offen sc1 lds
  s_add_u32 m0, m0, 1024
  s_add_u32 s57, s57, 1024
L_bgs_68:
  s_waitcnt lgkmcnt(2)
  v_mfma_f32_32x32x16_bf16 v[116:131], v[44:47], v[108:111], 0
  v_cvt_pk_bf16_f32 v112, v68, v69
  v_cvt_pk_bf16_f32 v113, v70, v71
  v_cvt_pk_bf16_f32 v114, v72, v73
  v_cvt_pk_bf16_f32 v115, v74, v75
  v_and_b32 v112, v112, v152
  v_and_b32 v113, v113, v153
  v_and_b32 v114, v114, v154
  v_and_b32 v115, v115, v155
  s_nop 1
  v_mfma_f32_32x32x16_bf16 v[116:131], v[48:51], v[112:115], v[116:131]
  s_cmp_le_u32 s93, 1
  s_cbranch_scc1 L_fastdone_63
  v_mfma_f32_32x32x16_bf16 v[60:75], v[20:23], v[4:7], 0
  s_mov_b64 exec, s[86:87]
  ds_read_b128 v[44:47], v159 offset:36864
  ds_read_b128 v[48:51], v159 offset:37888
  s_mov_b64 exec, -1
  s_cbranch_vccz L_bgs_69
  buffer_load_dwordx4 v1, s[8:11], s57 offen sc1 lds
  s_add_u32 m0, m0, 1024
  s_add_u32 s57, s57, 1024
L_bgs_69:
  v_exp_f32 v76, v76
  v_exp_f32 v77, v77
  v_exp_f32 v78, v78
  v_exp_f32 v79, v79
  v_exp_f32 v80, v80
  v_exp_f32 v81, v81
  v_exp_f32 v82, v82
  v_exp_f32 v83, v83
  v_cvt_pk_bf16_f32 v108, v76, v77
  v_cvt_pk_bf16_f32 v109, v78, v79
  v_cvt_pk_bf16_f32 v110, v80, v81
  v_cvt_pk_bf16_f32 v111, v82, v83
  v_exp_f32 v84, v84
  v_exp_f32 v85, v85
  v_exp_f32 v86, v86
  v_exp_f32 v87, v87
  v_exp_f32 v88, v88
  v_exp_f32 v89, v89
  v_exp_f32 v90, v90
  v_exp_f32 v91, v91
  s_cbranch_vccz L_bgs_70
  buffer_load_dwordx4 v1, s[8:11], s57 offen sc1 lds
  s_add_u32 m0, m0, 1024
  s_add_u32 s57, s57, 1024
L_bgs_70:
  s_waitcnt lgkmcnt(2)
  v_mfma_f32_32x32x16_bf16 v[116:131], v[52:55], v[108:111], v[116:131]
  v_cvt_pk_bf16_f32 v112, v84, v85
  v_cvt_pk_bf16_f32 v113, v86, v87
  v_cvt_pk_bf16_f32 v114, v88, v89
  v_cvt_pk_bf16_f32 v115, v90, v91
  s_nop 1
  v_mfma_f32_32x32x16_bf16 v[116:131], v[56:59], v[112:115], v[116:131]
  s_cmp_le_u32 s93, 2
  s_cbranch_scc1 L_fastdone_63
  v_mfma_f32_32x32x16_bf16 v[76:91], v[24:27], v[4:7], 0
  s_mov_b64 exec, s[86:87]
  ds_read_b128 v[52:55], v159 offset:34816
  ds_read_b128 v[56:59], v159 offset:35840
  s_mov_b64 exec, -1
  s_cbranch_vccz L_bgs_71
  buffer_load_dwordx4 v1, s[8:11], s57 offen sc1 lds
  s_add_u32 m0, m0, 1024
  s_add_u32 s57, s57, 1024
L_bgs_71:
  v_exp_f32 v92, v92
  v_exp_f32 v93, v93
  v_exp_f32 v94, v94
  v_exp_f32 v95, v95
  v_exp_f32 v96, v96
  v_exp_f32 v97, v97
  v_exp_f32 v98, v98
  v_exp_f32 v99, v99
  v_cvt_pk_bf16_f32 v108, v92, v93
  v_cvt_pk_bf16_f32 v109, v94, v95
  v_cvt_pk_bf16_f32 v110, v96, v97
  v_cvt_pk_bf16_f32 v111, v98, v99
  v_exp_f32 v100, v100
  v_exp_f32 v101, v101
  v_exp_f32 v102, v102
  v_exp_f32 v103, v103
  v_exp_f32 v104, v104
  v_exp_f32 v105, v105
  v_exp_f32 v106, v106
  v_exp_f32 v107, v107
  s_cbranch_vccz L_bgs_72
  buffer_load_dwordx4 v[180:183], v1, s[8:11], s60 offen offset:0 sc1
L_bgs_72:
  s_waitcnt lgkmcnt(2)
  v_mfma_f32_32x32x16_bf16 v[116:131], v[44:47], v[108:111], v[116:131]
  v_cvt_pk_bf16_f32 v112, v100, v101
  v_cvt_pk_bf16_f32 v113, v102, v103
  v_cvt_pk_bf16_f32 v114, v104, v105
  v_cvt_pk_bf16_f32 v115, v106, v107
  s_nop 1
  v_mfma_f32_32x32x16_bf16 v[116:131], v[48:51], v[112:115], v[116:131]
  s_cmp_le_u32 s93, 3
  s_cbranch_scc1 L_fastdone_63
  v_mfma_f32_32x32x16_bf16 v[92:107], v[28:31], v[4:7], 0
  s_mov_b64 exec, s[86:87]
  ds_read_b128 v[44:47], v159 offset:32768
  ds_read_b128 v[48:51], v159 offset:33792
  s_mov_b64 exec, -1
  s_cbranch_vccz L_bgs_73
  buffer_load_dwordx4 v[184:187], v1, s[8:11], s60 offen offset:1024 sc1
L_bgs_73:
  v_exp_f32 v60, v60
  v_exp_f32 v61, v61
  v_exp_f32 v62, v62
  v_exp_f32 v63, v63
  v_exp_f32 v64, v64
  v_exp_f32 v65, v65
  v_exp_f32 v66, v66
  v_exp_f32 v67, v67
  v_cvt_pk_bf16_f32 v108, v60, v61
  v_cvt_pk_bf16_f32 v109, v62, v63
  v_cvt_pk_bf16_f32 v110, v64, v65
  v_cvt_pk_bf16_f32 v111, v66, v67
  v_exp_f32 v68, v68
  v_exp_f32 v69, v69
  v_exp_f32 v70, v70
  v_exp_f32 v71, v71
  v_exp_f32 v72, v72
  v_exp_f32 v73, v73
  v_exp_f32 v74, v74
  v_exp_f32 v75, v75
  s_cbranch_vccz L_bgs_74
  buffer_load_dwordx4 v[188:191], v1, s[8:11], s60 offen offset:2048 sc1
L_bgs_74:
  s_waitcnt lgkmcnt(2)
  v_mfma_f32_32x32x16_bf16 v[116:131], v[52:55], v[108:111], v[116:131]
  v_cvt_pk_bf16_f32 v112, v68, v69
  v_cvt_pk_bf16_f32 v113, v70, v71
  v_cvt_pk_bf16_f32 v114, v72, v73
  v_cvt_pk_bf16_f32 v115, v74, v75
  s_nop 1
  v_mfma_f32_32x32x16_bf16 v[116:131], v[56:59], v[112:115], v[116:131]
  s_cmp_le_u32 s93, 4
  s_cbranch_scc1 L_fastdone_63
  v_mfma_f32_32x32x16_bf16 v[60:75], v[32:35], v[4:7], 0
  s_mov_b64 exec, s[86:87]
  ds_read_b128 v[52:55], v159 offset:30720
  ds_read_b128 v[56:59], v159 offset:31744
  s_mov_b64 exec, -1
  s_cbranch_vccz L_bgs_75
  buffer_load_dwordx4 v[192:195], v1, s[8:11], s60 offen offset:3072 sc1
L_bgs_75:
  v_exp_f32 v76, v76
  v_exp_f32 v77, v77
  v_exp_f32 v78, v78
  v_exp_f32 v79, v79
  v_exp_f32 v80, v80
  v_exp_f32 v81, v81
  v_exp_f32 v82, v82
  v_exp_f32 v83, v83
  v_cvt_pk_bf16_f32 v108, v76, v77
  v_cvt_pk_bf16_f32 v109, v78, v79
  v_cvt_pk_bf16_f32 v110, v80, v81
  v_cvt_pk_bf16_f32 v111, v82, v83
  v_exp_f32 v84, v84
  v_exp_f32 v85, v85
  v_exp_f32 v86, v86
  v_exp_f32 v87, v87
  v_exp_f32 v88, v88
  v_exp_f32 v89, v89
  v_exp_f32 v90, v90
  v_exp_f32 v91, v91
  s_cbranch_vccz L_bgs_76
  s_add_u32 s60, s60, 4096
  buffer_load_dwordx4 v[196:199], v1, s[8:11], s60 offen offset:0 sc1
L_bgs_76:
  s_waitcnt lgkmcnt(2)
  v_mfma_f32_32x32x16_bf16 v[116:131], v[44:47], v[108:111], v[116:131]
  v_cvt_pk_bf16_f32 v112, v84, v85
  v_cvt_pk_bf16_f32 v113, v86, v87
  v_cvt_pk_bf16_f32 v114, v88, v89
  v_cvt_pk_bf16_f32 v115, v90, v91
  s_nop 1
  v_mfma_f32_32x32x16_bf16 v[116:131], v[48:51], v[112:115], v[116:131]
  s_cmp_le_u32 s93, 5
  s_cbranch_scc1 L_fastdone_63
  v_mfma_f32_32x32x16_bf16 v[76:91], v[36:39], v[4:7], 0
  s_mov_b64 exec, s[86:87]
  ds_read_b128 v[44:47], v159 offset:28672
  ds_read_b128 v[48:51], v159 offset:29696
  s_mov_b64 exec, -1
  s_cbranch_vccz L_bgs_77
  buffer_load_dwordx4 v[200:203], v1, s[8:11], s60 offen offset:1024 sc1
L_bgs_77:
  v_exp_f32 v92, v92
  v_exp_f32 v93, v93
  v_exp_f32 v94, v94
  v_exp_f32 v95, v95
  v_exp_f32 v96, v96
  v_exp_f32 v97, v97
  v_exp_f32 v98, v98
  v_exp_f32 v99, v99
  v_cvt_pk_bf16_f32 v108, v92, v93
  v_cvt_pk_bf16_f32 v109, v94, v95
  v_cvt_pk_bf16_f32 v110, v96, v97
  v_cvt_pk_bf16_f32 v111, v98, v99
  v_exp_f32 v100, v100
  v_exp_f32 v101, v101
  v_exp_f32 v102, v102
  v_exp_f32 v103, v103
  v_exp_f32 v104, v104
  v_exp_f32 v105, v105
  v_exp_f32 v106, v106
  v_exp_f32 v107, v107
  s_cbranch_vccz L_bgs_78
  buffer_load_dwordx4 v[204:207], v1, s[8:11], s60 offen offset:2048 sc1
L_bgs_78:
  s_waitcnt lgkmcnt(2)
  v_mfma_f32_32x32x16_bf16 v[116:131], v[52:55], v[108:111], v[116:131]
  v_cvt_pk_bf16_f32 v112, v100, v101
  v_cvt_pk_bf16_f32 v113, v102, v103
  v_cvt_pk_bf16_f32 v114, v104, v105
  v_cvt_pk_bf16_f32 v115, v106, v107
  s_nop 1
  v_mfma_f32_32x32x16_bf16 v[116:131], v[56:59], v[112:115], v[116:131]
  s_cmp_le_u32 s93, 6
  s_cbranch_scc1 L_fastdone_63
  v_mfma_f32_32x32x16_bf16 v[92:107], v[40:43], v[4:7], 0
  s_mov_b64 exec, s[86:87]
  ds_read_b128 v[52:55], v159 offset:26624
  ds_read_b128 v[56:59], v159 offset:27648
  s_mov_b64 exec, -1
  s_cbranch_vccz L_bgs_79
  buffer_load_dwordx4 v[208:211], v1, s[8:11], s60 offen offset:3072 sc1
L_bgs_79:
  v_exp_f32 v60, v60
  v_exp_f32 v61, v61
  v_exp_f32 v62, v62
  v_exp_f32 v63, v63
  v_exp_f32 v64, v64
  v_exp_f32 v65, v65
  v_exp_f32 v66, v66
  v_exp_f32 v67, v67
  v_cvt_pk_bf16_f32 v108, v60, v61
  v_cvt_pk_bf16_f32 v109, v62, v63
  v_cvt_pk_bf16_f32 v110, v64, v65
  v_cvt_pk_bf16_f32 v111, v66, v67
  v_exp_f32 v68, v68
  v_exp_f32 v69, v69
  v_exp_f32 v70, v70
  v_exp_f32 v71, v71
  v_exp_f32 v72, v72
  v_exp_f32 v73, v73
  v_exp_f32 v74, v74
  v_exp_f32 v75, v75
  s_cbranch_vccz L_bgs_80
  s_add_u32 s60, s60, 4096
  buffer_load_dwordx4 v[212:215], v1, s[8:11], s60 offen offset:0 sc1
L_bgs_80:
  s_waitcnt lgkmcnt(2)
  v_mfma_f32_32x32x16_bf16 v[116:131], v[44:47], v[108:111], v[116:131]
  v_cvt_pk_bf16_f32 v112, v68, v69
  v_cvt_pk_bf16_f32 v113, v70, v71
  v_cvt_pk_bf16_f32 v114, v72, v73
  v_cvt_pk_bf16_f32 v115, v74, v75
  s_nop 1
  v_mfma_f32_32x32x16_bf16 v[116:131], v[48:51], v[112:115], v[116:131]
  s_cmp_le_u32 s93, 7
  s_cbranch_scc1 L_fastdone_63
  s_mov_b64 exec, s[86:87]
  ds_read_b128 v[44:47], v159 offset:24576
  ds_read_b128 v[48:51], v159 offset:25600
  s_mov_b64 exec, -1
  s_cbranch_vccz L_bgs_81
  buffer_load_dwordx4 v[216:219], v1, s[8:11], s60 offen offset:1024 sc1
L_bgs_81:
  v_exp_f32 v76, v76
  v_exp_f32 v77, v77
  v_exp_f32 v78, v78
  v_exp_f32 v79, v79
  v_exp_f32 v80, v80
  v_exp_f32 v81, v81
  v_exp_f32 v82, v82
  v_exp_f32 v83, v83
  v_cvt_pk_bf16_f32 v108, v76, v77
  v_cvt_pk_bf16_f32 v109, v78, v79
  v_cvt_pk_bf16_f32 v110, v80, v81
  v_cvt_pk_bf16_f32 v111, v82, v83
  v_exp_f32 v84, v84
  v_exp_f32 v85, v85
  v_exp_f32 v86, v86
  v_exp_f32 v87, v87
  v_exp_f32 v88, v88
  v_exp_f32 v89, v89
  v_exp_f32 v90, v90
  v_exp_f32 v91, v91
  s_cbranch_vccz L_bgs_82
  buffer_load_dwordx4 v[220:223], v1, s[8:11], s60 offen offset:2048 sc1
L_bgs_82:
  s_waitcnt lgkmcnt(2)
  v_mfma_f32_32x32x16_bf16 v[116:131], v[52:55], v[108:111], v[116:131]
  v_cvt_pk_bf16_f32 v112, v84, v85
  v_cvt_pk_bf16_f32 v113, v86, v87
  v_cvt_pk_bf16_f32 v114, v88, v89
  v_cvt_pk_bf16_f32 v115, v90, v91
  s_nop 1
  v_mfma_f32_32x32x16_bf16 v[116:131], v[56:59], v[112:115], v[116:131]
  s_cmp_le_u32 s93, 8
  s_cbranch_scc1 L_fastdone_63
  s_cbranch_vccz L_bgs_83
  buffer_load_dwordx4 v[224:227], v1, s[8:11], s60 offen offset:3072 sc1
L_bgs_83:
  v_exp_f32 v92, v92
  v_exp_f32 v93, v93
  v_exp_f32 v94, v94
  v_exp_f32 v95, v95
  v_exp_f32 v96, v96
  v_exp_f32 v97, v97
  v_exp_f32 v98, v98
  v_exp_f32 v99, v99
  v_cvt_pk_bf16_f32 v108, v92, v93
  v_cvt_pk_bf16_f32 v109, v94, v95
  v_cvt_pk_bf16_f32 v110, v96, v97
  v_cvt_pk_bf16_f32 v111, v98, v99
  v_bfi_b32 v108, v148, 0, v108
  v_bfi_b32 v109, v149, 0, v109
  v_bfi_b32 v110, v150, 0, v110
  v_bfi_b32 v111, v151, 0, v111
  v_exp_f32 v100, v100
  v_exp_f32 v101, v101
  v_exp_f32 v102, v102
  v_exp_f32 v103, v103
  v_exp_f32 v104, v104
  v_exp_f32 v105, v105
  v_exp_f32 v106, v106
  v_exp_f32 v107, v107
  s_waitcnt lgkmcnt(0)
  v_mfma_f32_32x32x16_bf16 v[116:131], v[44:47], v[108:111], v[116:131]
  v_cvt_pk_bf16_f32 v112, v100, v101
  v_cvt_pk_bf16_f32 v113, v102, v103
  v_cvt_pk_bf16_f32 v114, v104, v105
  v_cvt_pk_bf16_f32 v115, v106, v107
  v_bfi_b32 v112, v152, 0, v112
  v_bfi_b32 v113, v153, 0, v113
  v_bfi_b32 v114, v154, 0, v114
  v_bfi_b32 v115, v155, 0, v115
  s_nop 1
  v_mfma_f32_32x32x16_bf16 v[116:131], v[48:51], v[112:115], v[116:131]
  s_cbranch_vccz L_bgs_84
  s_add_u32 s60, s60, 4096
  buffer_load_dwordx4 v[228:231], v1, s[8:11], s60 offen offset:0 sc1
L_bgs_84:
  s_cbranch_vccz L_bgs_85
  buffer_load_dwordx4 v[232:235], v1, s[8:11], s60 offen offset:1024 sc1
L_bgs_85:
  s_cbranch_vccz L_bgs_86
  buffer_load_dwordx4 v[236:239], v1, s[8:11], s60 offen offset:2048 sc1
L_bgs_86:
  s_cbranch_vccz L_bgs_87
  buffer_load_dwordx4 v[240:243], v1, s[8:11], s60 offen offset:3072 sc1
L_bgs_87:
L_fastdone_63:
  s_nop 13
  v_max3_f32 v156, |v116|, |v117|, |v118|
  v_max3_f32 v156, |v119|, |v120|, v156
  v_max3_f32 v156, |v121|, |v122|, v156
  v_max_f32 v156, |v123|, v156
  s_mov_b32 s52, 0x2b800000
  s_mov_b32 s53, 0x53800000
  s_mov_b32 s54, 0x7b800000
  v_cmp_le_f32 vcc, s52, v124
  v_cmp_ge_f32 s[62:63], s53, v124
  s_and_b64 vcc, vcc, s[62:63]
  v_cmp_ge_f32 s[62:63], s54, v156
  s_and_b64 vcc, vcc, s[62:63]
  s_cmp_eq_u64 vcc, -1
  s_cbranch_scc1 L_att_fin_60
  s_waitcnt lgkmcnt(0)
  ds_read_b128 v[60:63], v160 offset:0
  ds_read_b128 v[64:67], v160 offset:1024
  ds_read_b128 v[68:71], v160 offset:2048
  ds_read_b128 v[72:75], v160 offset:3072
  v_mov_b32 v156, 0xf149f2ca
  s_waitcnt lgkmcnt(0)
  v_mfma_f32_32x32x16_bf16 v[60:75], v[8:11], v[4:7], v[60:75]
  s_nop 13
  v_max3_f32 v156, v60, v61, v156
  v_max3_f32 v156, v62, v63, v156
  v_max3_f32 v156, v64, v65, v156
  v_max3_f32 v156, v66, v67, v156
  v_max3_f32 v156, v68, v69, v156
  v_max3_f32 v156, v70, v71, v156
  v_max3_f32 v156, v72, v73, v156
  v_max3_f32 v156, v74, v75, v156
  s_cmp_le_u32 s93, 1
  s_cbranch_scc1 L_p1done_88
  v_mfma_f32_32x32x16_bf16 v[76:91], v[12:15], v[4:7], 0
  s_nop 13
  v_max3_f32 v156, v76, v77, v156
  v_max3_f32 v156, v78, v79, v156
  v_max3_f32 v156, v80, v81, v156
  v_max3_f32 v156, v82, v83, v156
  v_max3_f32 v156, v84, v85, v156
  v_max3_f32 v156, v86, v87, v156
  v_max3_f32 v156, v88, v89, v156
  v_max3_f32 v156, v90, v91, v156
  s_cmp_le_u32 s93, 2
  s_cbranch_scc1 L_p1done_88
  v_mfma_f32_32x32x16_bf16 v[92:107], v[16:19], v[4:7], 0
  s_nop 13
  v_max3_f32 v156, v92, v93, v156
  v_max3_f32 v156, v94, v95, v156
  v_max3_f32 v156, v96, v97, v156
  v_max3_f32 v156, v98, v99, v156
  v_max3_f32 v156, v100, v101, v156
  v_max3_f32 v156, v102, v103, v156
  v_max3_f32 v156, v104, v105, v156
  v_max3_f32 v156, v106, v107, v156
  s_cmp_le_u32 s93, 3
  s_cbranch_scc1 L_p1done_88
  v_mfma_f32_32x32x16_bf16 v[60:75], v[20:23], v[4:7], 0
  s_nop 13
  v_max3_f32 v156, v60, v61, v156
  v_max3_f32 v156, v62, v63, v156
  v_max3_f32 v156, v64, v65, v156
  v_max3_f32 v156, v66, v67, v156
  v_max3_f32 v156, v68, v69, v156
  v_max3_f32 v156, v70, v71, v156
  v_max3_f32 v156, v72, v73, v156
  v_max3_f32 v156, v74, v75, v156
  s_cmp_le_u32 s93, 4
  s_cbranch_scc1 L_p1done_88
  v_mfma_f32_32x32x16_bf16 v[76:91], v[24:27], v[4:7], 0
  s_nop 13
  v_max3_f32 v156, v76, v77, v156
  v_max3_f32 v156, v78, v79, v156
  v_max3_f32 v156, v80, v81, v156
  v_max3_f32 v156, v82, v83, v156
  v_max3_f32 v156, v84, v85, v156
  v_max3_f32 v156, v86, v87, v156
  v_max3_f32 v156, v88, v89, v156
  v_max3_f32 v156, v90, v91, v156
  s_cmp_le_u32 s93, 5
  s_cbranch_scc1 L_p1done_88
  v_mfma_f32_32x32x16_bf16 v[92:107], v[28:31], v[4:7], 0
  s_nop 13
  v_max3_f32 v156, v92, v93, v156
  v_max3_f32 v156, v94, v95, v156
  v_max3_f32 v156, v96, v97, v156
  v_max3_f32 v156, v98, v99, v156
  v_max3_f32 v156, v100, v101, v156
  v_max3_f32 v156, v102, v103, v156
  v_max3_f32 v156, v104, v105, v156
  v_max3_f32 v156, v106, v107, v156
  s_cmp_le_u32 s93, 6
  s_cbranch_scc1 L_p1done_88
  v_mfma_f32_32x32x16_bf16 v[60:75], v[32:35], v[4:7], 0
  s_nop 13
  v_max3_f32 v156, v60, v61, v156
  v_max3_f32 v156, v62, v63, v156
  v_max3_f32 v156, v64, v65, v156
  v_max3_f32 v156, v66, v67, v156
  v_max3_f32 v156, v68, v69, v156
  v_max3_f32 v156, v70, v71, v156
  v_max3_f32 v156, v72, v73, v156
  v_max3_f32 v156, v74, v75, v156
  s_cmp_le_u32 s93, 7
  s_cbranch_scc1 L_p1done_88
  v_mfma_f32_32x32x16_bf16 v[76:91], v[36:39], v[4:7], 0
  s_nop 13
  v_max3_f32 v156, v76, v77, v156
  v_max3_f32 v156, v78, v79, v156
  v_max3_f32 v156, v80, v81, v156
  v_max3_f32 v156, v82, v83, v156
  v_max3_f32 v156, v84, v85, v156
  v_max3_f32 v156, v86, v87, v156
  v_max3_f32 v156, v88, v89, v156
  v_max3_f32 v156, v90, v91, v156
  s_cmp_le_u32 s93, 8
  s_cbranch_scc1 L_p1done_88
  ds_read_b128 v[92:95], v160 offset:4096
  ds_read_b128 v[96:99], v160 offset:5120
  ds_read_b128 v[100:103], v160 offset:6144
  ds_read_b128 v[104:107], v160 offset:7168
  s_waitcnt lgkmcnt(0)
  v_mfma_f32_32x32x16_bf16 v[92:107], v[40:43], v[4:7], v[92:107]
  s_nop 13
  v_max3_f32 v156, v92, v93, v156
  v_max3_f32 v156, v94, v95, v156
  v_max3_f32 v156, v96, v97, v156
  v_max3_f32 v156, v98, v99, v156
  v_max3_f32 v156, v100, v101, v156
  v_max3_f32 v156, v102, v103, v156
  v_max3_f32 v156, v104, v105, v156
  v_max3_f32 v156, v106, v107, v156
L_p1done_88:
  v_mov_b32 v157, v156
  s_nop 1
  v_permlane32_swap_b32 v157, v156
  s_nop 0
  v_max_f32 v156, v156, v157
  v_sub_f32 v156, 0, v156
  v_mov_b32 v132, v156
  v_mov_b32 v133, v156
  v_mov_b32 v134, v156
  v_mov_b32 v135, v156
  v_mov_b32 v136, v156
  v_mov_b32 v137, v156
  v_mov_b32 v138, v156
  v_mov_b32 v139, v156
  v_mov_b32 v140, v156
  v_mov_b32 v141, v156
  v_mov_b32 v142, v156
  v_mov_b32 v143, v156
  v_mov_b32 v144, v156
  v_mov_b32 v145, v156
  v_mov_b32 v146, v156
  v_mov_b32 v147, v156
  s_nop 1
  v_mfma_f32_32x32x16_bf16 v[60:75], v[8:11], v[4:7], v[132:147]
  s_mov_b64 exec, s[86:87]
  ds_read_b128 v[44:47], v159 offset:40960
  ds_read_b128 v[48:51], v159 offset:41984
  s_mov_b64 exec, -1
  s_nop 11
  v_exp_f32 v60, v60
  v_exp_f32 v61, v61
  v_exp_f32 v62, v62
  v_exp_f32 v63, v63
  v_exp_f32 v64, v64
  v_exp_f32 v65, v65
  v_exp_f32 v66, v66
  v_exp_f32 v67, v67
  v_cvt_pk_bf16_f32 v108, v60, v61
  v_cvt_pk_bf16_f32 v109, v62, v63
  v_cvt_pk_bf16_f32 v110, v64, v65
  v_cvt_pk_bf16_f32 v111, v66, v67
  v_and_b32 v108, v108, v148
  v_and_b32 v109, v109, v149
  v_and_b32 v110, v110, v150
  v_and_b32 v111, v111, v151
  v_exp_f32 v68, v68
  v_exp_f32 v69, v69
  v_exp_f32 v70, v70
  v_exp_f32 v71, v71
  v_exp_f32 v72, v72
  v_exp_f32 v73, v73
  v_exp_f32 v74, v74
  v_exp_f32 v75, v75
  s_waitcnt lgkmcnt(0)
  v_mfma_f32_32x32x16_bf16 v[116:131], v[44:47], v[108:111], 0
  v_cvt_pk_bf16_f32 v112, v68, v69
  v_cvt_pk_bf16_f32 v113, v70, v71
  v_cvt_pk_bf16_f32 v114, v72, v73
  v_cvt_pk_bf16_f32 v115, v74, v75
  v_and_b32 v112, v112, v152
  v_and_b32 v113, v113, v153
  v_and_b32 v114, v114, v154
  v_and_b32 v115, v115, v155
  s_nop 1
  v_mfma_f32_32x32x16_bf16 v[116:131], v[48:51], v[112:115], v[116:131]
  s_cmp_le_u32 s93, 1
  s_cbranch_scc1 L_p2done_89
  v_mfma_f32_32x32x16_bf16 v[76:91], v[12:15], v[4:7], v[132:147]
  s_mov_b64 exec, s[86:87]
  ds_read_b128 v[52:55], v159 offset:38912
  ds_read_b128 v[56:59], v159 offset:39936
  s_mov_b64 exec, -1
  s_nop 11
  v_exp_f32 v76, v76
  v_exp_f32 v77, v77
  v_exp_f32 v78, v78
  v_exp_f32 v79, v79
  v_exp_f32 v80, v80
  v_exp_f32 v81, v81
  v_exp_f32 v82, v82
  v_exp_f32 v83, v83
  v_cvt_pk_bf16_f32 v108, v76, v77
  v_cvt_pk_bf16_f32 v109, v78, v79
  v_cvt_pk_bf16_f32 v110, v80, v81
  v_cvt_pk_bf16_f32 v111, v82, v83
  v_exp_f32 v84, v84
  v_exp_f32 v85, v85
  v_exp_f32 v86, v86
  v_exp_f32 v87, v87
  v_exp_f32 v88, v88
  v_exp_f32 v89, v89
  v_exp_f32 v90, v90
  v_exp_f32 v91, v91
  s_waitcnt lgkmcnt(0)
  v_mfma_f32_32x32x16_bf16 v[116:131], v[52:55], v[108:111], v[116:131]
  v_cvt_pk_bf16_f32 v112, v84, v85
  v_cvt_pk_bf16_f32 v113, v86, v87
  v_cvt_pk_bf16_f32 v114, v88, v89
  v_cvt_pk_bf16_f32 v115, v90, v91
  s_nop 1
  v_mfma_f32_32x32x16_bf16 v[116:131], v[56:59], v[112:115], v[116:131]
  s_cmp_le_u32 s93, 2
  s_cbranch_scc1 L_p2done_89
  v_mfma_f32_32x32x16_bf16 v[92:107], v[16:19], v[4:7], v[132:147]
  s_mov_b64 exec, s[86:87]
  ds_read_b128 v[44:47], v159 offset:36864
  ds_read_b128 v[48:51], v159 offset:37888
  s_mov_b64 exec, -1
  s_nop 11
  v_exp_f32 v92, v92
  v_exp_f32 v93, v93
  v_exp_f32 v94, v94
  v_exp_f32 v95, v95
  v_exp_f32 v96, v96
  v_exp_f32 v97, v97
  v_exp_f32 v98, v98
  v_exp_f32 v99, v99
  v_cvt_pk_bf16_f32 v108, v92, v93
  v_cvt_pk_bf16_f32 v109, v94, v95
  v_cvt_pk_bf16_f32 v110, v96, v97
  v_cvt_pk_bf16_f32 v111, v98, v99
  v_exp_f32 v100, v100
  v_exp_f32 v101, v101
  v_exp_f32 v102, v102
  v_exp_f32 v103, v103
  v_exp_f32 v104, v104
  v_exp_f32 v105, v105
  v_exp_f32 v106, v106
  v_exp_f32 v107, v107
  s_waitcnt lgkmcnt(0)
  v_mfma_f32_32x32x16_bf16 v[116:131], v[44:47], v[108:111], v[116:131]
  v_cvt_pk_bf16_f32 v112, v100, v101
  v_cvt_pk_bf16_f32 v113, v102, v103
  v_cvt_pk_bf16_f32 v114, v104, v105
  v_cvt_pk_bf16_f32 v115, v106, v107
  s_nop 1
  v_mfma_f32_32x32x16_bf16 v[116:131], v[48:51], v[112:115], v[116:131]
  s_cmp_le_u32 s93, 3
  s_cbranch_scc1 L_p2done_89
  v_mfma_f32_32x32x16_bf16 v[60:75], v[20:23], v[4:7], v[132:147]
  s_mov_b64 exec, s[86:87]
  ds_read_b128 v[52:55], v159 offset:34816
  ds_read_b128 v[56:59], v159 offset:35840
  s_mov_b64 exec, -1
  s_nop 11
  v_exp_f32 v60, v60
  v_exp_f32 v61, v61
  v_exp_f32 v62, v62
  v_exp_f32 v63, v63
  v_exp_f32 v64, v64
  v_exp_f32 v65, v65
  v_exp_f32 v66, v66
  v_exp_f32 v67, v67
  v_cvt_pk_bf16_f32 v108, v60, v61
  v_cvt_pk_bf16_f32 v109, v62, v63
  v_cvt_pk_bf16_f32 v110, v64, v65
  v_cvt_pk_bf16_f32 v111, v66, v67
  v_exp_f32 v68, v68
  v_exp_f32 v69, v69
  v_exp_f32 v70, v70
  v_exp_f32 v71, v71
  v_exp_f32 v72, v72
  v_exp_f32 v73, v73
  v_exp_f32 v74, v74
  v_exp_f32 v75, v75
  s_waitcnt lgkmcnt(0)
  v_mfma_f32_32x32x16_bf16 v[116:131], v[52:55], v[108:111], v[116:131]
  v_cvt_pk_bf16_f32 v112, v68, v69
  v_cvt_pk_bf16_f32 v113, v70, v71
  v_cvt_pk_bf16_f32 v114, v72, v73
  v_cvt_pk_bf16_f32 v115, v74, v75
  s_nop 1
  v_mfma_f32_32x32x16_bf16 v[116:131], v[56:59], v[112:115], v[116:131]
  s_cmp_le_u32 s93, 4
  s_cbranch_scc1 L_p2done_89
  v_mfma_f32_32x32x16_bf16 v[76:91], v[24:27], v[4:7], v[132:147]
  s_mov_b64 exec, s[86:87]
  ds_read_b128 v[44:47], v159 offset:32768
  ds_read_b128 v[48:51], v159 offset:33792
  s_mov_b64 exec, -1
  s_nop 11
  v_exp_f32 v76, v76
  v_exp_f32 v77, v77
  v_exp_f32 v78, v78
  v_exp_f32 v79, v79
  v_exp_f32 v80, v80
  v_exp_f32 v81, v81
  v_exp_f32 v82, v82
  v_exp_f32 v83, v83
  v_cvt_pk_bf16_f32 v108, v76, v77
  v_cvt_pk_bf16_f32 v109, v78, v79
  v_cvt_pk_bf16_f32 v110, v80, v81
  v_cvt_pk_bf16_f32 v111, v82, v83
  v_exp_f32 v84, v84
  v_exp_f32 v85, v85
  v_exp_f32 v86, v86
  v_exp_f32 v87, v87
  v_exp_f32 v88, v88
  v_exp_f32 v89, v89
  v_exp_f32 v90, v90
  v_exp_f32 v91, v91
  s_waitcnt lgkmcnt(0)
  v_mfma_f32_32x32x16_bf16 v[116:131], v[44:47], v[108:111], v[116:131]
  v_cvt_pk_bf16_f32 v112, v84, v85
  v_cvt_pk_bf16_f32 v113, v86, v87
  v_cvt_pk_bf16_f32 v114, v88, v89
  v_cvt_pk_bf16_f32 v115, v90, v91
  s_nop 1
  v_mfma_f32_32x32x16_bf16 v[116:131], v[48:51], v[112:115], v[116:131]
  s_cmp_le_u32 s93, 5
  s_cbranch_scc1 L_p2done_89
  v_mfma_f32_32x32x16_bf16 v[92:107], v[28:31], v[4:7], v[132:147]
  s_mov_b64 exec, s[86:87]
  ds_read_b128 v[52:55], v159 offset:30720
  ds_read_b128 v[56:59], v159 offset:31744
  s_mov_b64 exec, -1
  s_nop 11
  v_exp_f32 v92, v92
  v_exp_f32 v93, v93
  v_exp_f32 v94, v94
  v_exp_f32 v95, v95
  v_exp_f32 v96, v96
  v_exp_f32 v97, v97
  v_exp_f32 v98, v98
  v_exp_f32 v99, v99
  v_cvt_pk_bf16_f32 v108, v92, v93
  v_cvt_pk_bf16_f32 v109, v94, v95
  v_cvt_pk_bf16_f32 v110, v96, v97
  v_cvt_pk_bf16_f32 v111, v98, v99
  v_exp_f32 v100, v100
  v_exp_f32 v101, v101
  v_exp_f32 v102, v102
  v_exp_f32 v103, v103
  v_exp_f32 v104, v104
  v_exp_f32 v105, v105
  v_exp_f32 v106, v106
  v_exp_f32 v107, v107
  s_waitcnt lgkmcnt(0)
  v_mfma_f32_32x32x16_bf16 v[116:131], v[52:55], v[108:111], v[116:131]
  v_cvt_pk_bf16_f32 v112, v100, v101
  v_cvt_pk_bf16_f32 v113, v102, v103
  v_cvt_pk_bf16_f32 v114, v104, v105
  v_cvt_pk_bf16_f32 v115, v106, v107
  s_nop 1
  v_mfma_f32_32x32x16_bf16 v[116:131], v[56:59], v[112:115], v[116:131]
  s_cmp_le_u32 s93, 6
  s_cbranch_scc1 L_p2done_89
  v_mfma_f32_32x32x16_bf16 v[60:75], v[32:35], v[4:7], v[132:147]
  s_mov_b64 exec, s[86:87]
  ds_read_b128 v[44:47], v159 offset:28672
  ds_read_b128 v[48:51], v159 offset:29696
  s_mov_b64 exec, -1
  s_nop 11
  v_exp_f32 v60, v60
  v_exp_f32 v61, v61
  v_exp_f32 v62, v62
  v_exp_f32 v63, v63
  v_exp_f32 v64, v64
  v_exp_f32 v65, v65
  v_exp_f32 v66, v66
  v_exp_f32 v67, v67
  v_cvt_pk_bf16_f32 v108, v60, v61
  v_cvt_pk_bf16_f32 v109, v62, v63
  v_cvt_pk_bf16_f32 v110, v64, v65
  v_cvt_pk_bf16_f32 v111, v66, v67
  v_exp_f32 v68, v68
  v_exp_f32 v69, v69
  v_exp_f32 v70, v70
  v_exp_f32 v71, v71
  v_exp_f32 v72, v72
  v_exp_f32 v73, v73
  v_exp_f32 v74, v74
  v_exp_f32 v75, v75
  s_waitcnt lgkmcnt(0)
  v_mfma_f32_32x32x16_bf16 v[116:131], v[44:47], v[108:111], v[116:131]
  v_cvt_pk_bf16_f32 v112, v68, v69
  v_cvt_pk_bf16_f32 v113, v70, v71
  v_cvt_pk_bf16_f32 v114, v72, v73
  v_cvt_pk_bf16_f32 v115, v74, v75
  s_nop 1
  v_mfma_f32_32x32x16_bf16 v[116:131], v[48:51], v[112:115], v[116:131]
  s_cmp_le_u32 s93, 7
  s_cbranch_scc1 L_p2done_89
  v_mfma_f32_32x32x16_bf16 v[76:91], v[36:39], v[4:7], v[132:147]
  s_mov_b64 exec, s[86:87]
  ds_read_b128 v[52:55], v159 offset:26624
  ds_read_b128 v[56:59], v159 offset:27648
  s_mov_b64 exec, -1
  s_nop 11
  v_exp_f32 v76, v76
  v_exp_f32 v77, v77
  v_exp_f32 v78, v78
  v_exp_f32 v79, v79
  v_exp_f32 v80, v80
  v_exp_f32 v81, v81
  v_exp_f32 v82, v82
  v_exp_f32 v83, v83
  v_cvt_pk_bf16_f32 v108, v76, v77
  v_cvt_pk_bf16_f32 v109, v78, v79
  v_cvt_pk_bf16_f32 v110, v80, v81
  v_cvt_pk_bf16_f32 v111, v82, v83
  v_exp_f32 v84, v84
  v_exp_f32 v85, v85
  v_exp_f32 v86, v86
  v_exp_f32 v87, v87
  v_exp_f32 v88, v88
  v_exp_f32 v89, v89
  v_exp_f32 v90, v90
  v_exp_f32 v91, v91
  s_waitcnt lgkmcnt(0)
  v_mfma_f32_32x32x16_bf16 v[116:131], v[52:55], v[108:111], v[116:131]
  v_cvt_pk_bf16_f32 v112, v84, v85
  v_cvt_pk_bf16_f32 v113, v86, v87
  v_cvt_pk_bf16_f32 v114, v88, v89
  v_cvt_pk_bf16_f32 v115, v90, v91
  s_nop 1
  v_mfma_f32_32x32x16_bf16 v[116:131], v[56:59], v[112:115], v[116:131]
  s_cmp_le_u32 s93, 8
  s_cbranch_scc1 L_p2done_89
  v_mfma_f32_32x32x16_bf16 v[92:107], v[40:43], v[4:7], v[132:147]
  s_mov_b64 exec, s[86:87]
  ds_read_b128 v[44:47], v159 offset:24576
  ds_read_b128 v[48:51], v159 offset:25600
  s_mov_b64 exec, -1
  s_nop 11
  v_exp_f32 v92, v92
  v_exp_f32 v93, v93
  v_exp_f32 v94, v94
  v_exp_f32 v95, v95
  v_exp_f32 v96, v96
  v_exp_f32 v97, v97
  v_exp_f32 v98, v98
  v_exp_f32 v99, v99
  v_cvt_pk_bf16_f32 v108, v92, v93
  v_cvt_pk_bf16_f32 v109, v94, v95
  v_cvt_pk_bf16_f32 v110, v96, v97
  v_cvt_pk_bf16_f32 v111, v98, v99
  v_bfi_b32 v108, v148, 0, v108
  v_bfi_b32 v109, v149, 0, v109
  v_bfi_b32 v110, v150, 0, v110
  v_bfi_b32 v111, v151, 0, v111
  v_exp_f32 v100, v100
  v_exp_f32 v101, v101
  v_exp_f32 v102, v102
  v_exp_f32 v103, v103
  v_exp_f32 v104, v104
  v_exp_f32 v105, v105
  v_exp_f32 v106, v106
  v_exp_f32 v107, v107
  s_waitcnt lgkmcnt(0)
  v_mfma_f32_32x32x16_bf16 v[116:131], v[44:47], v[108:111], v[116:131]
  v_cvt_pk_bf16_f32 v112, v100, v101
  v_cvt_pk_bf16_f32 v113, v102, v103
  v_cvt_pk_bf16_f32 v114, v104, v105
  v_cvt_pk_bf16_f32 v115, v106, v107
  v_bfi_b32 v112, v152, 0, v112
  v_bfi_b32 v113, v153, 0, v113
  v_bfi_b32 v114, v154, 0, v114
  v_bfi_b32 v115, v155, 0, v115
  s_nop 1
  v_mfma_f32_32x32x16_bf16 v[116:131], v[48:51], v[112:115], v[116:131]
L_p2done_89:
L_att_fin_60:
  s_nop 13
  v_rcp_f32 v156, v124
  s_nop 0
  v_mul_f32 v116, v116, v156
  v_mul_f32 v117, v117, v156
  v_mul_f32 v118, v118, v156
  v_mul_f32 v119, v119, v156
  v_mul_f32 v120, v120, v156
  v_mul_f32 v121, v121, v156
  v_mul_f32 v122, v122, v156
  v_mul_f32 v123, v123, v156
  v_cvt_pk_bf16_f32 v108, v116, v117
  v_cvt_pk_bf16_f32 v109, v118, v119
  v_cvt_pk_bf16_f32 v110, v120, v121
  v_cvt_pk_bf16_f32 v111, v122, v123
  s_and_b32 s52, s46, 3
  s_lshr_b32 s53, s46, 2
  s_lshl_b32 s54, s44, 2
  s_add_u32 s54, s54, s52
  s_lshl_b32 s54, s54, 15
  s_lshl_b32 s55, s45, 11
  s_add_u32 s54, s54, s55
  s_lshl_b32 s55, s53, 10
  s_add_u32 s54, s54, s55
  s_add_u32 s54, s54, 5242880
  s_cmp_eq_u32 s47, 1
  s_cbranch_scc1 L_fast_90
  buffer_store_dwordx4 v[108:111], v1, s[8:11], s54 offen sc1
  s_branch L_join_91
L_fast_90:
  buffer_store_dwordx4 v[108:111], v1, s[8:11], s54 offen
L_join_91:
  s_waitcnt vmcnt(0)
  s_barrier
  s_cmp_ge_u32 s46, 4
  s_cbranch_scc1 L_p3_helper
  s_lshl_b32 s52, s48, 2
  s_add_u32 s52, s52, 1
  v_mov_b32 v4, s52
  v_mov_b32 v5, 0
  s_mov_b64 exec, 1
  s_cmp_eq_u32 s47, 1
  s_cbranch_scc1 L_fast_92
  buffer_store_dword v4, v5, s[8:11], s50 offen sc1
  s_branch L_join_93
L_fast_92:
  buffer_store_dword v4, v5, s[8:11], s50 offen
L_join_93:
  s_mov_b64 exec, -1
  s_lshl_b32 s52, s46, 14
  v_add_u32 v7, s52, v1
  ds_write_b128 v7, v[180:183] offset:0
  ds_write_b128 v7, v[184:187] offset:1024
  ds_write_b128 v7, v[188:191] offset:2048
  ds_write_b128 v7, v[192:195] offset:3072
  ds_write_b128 v7, v[196:199] offset:4096
  ds_write_b128 v7, v[200:203] offset:5120
  ds_write_b128 v7, v[204:207] offset:6144
  ds_write_b128 v7, v[208:211] offset:7168
  ds_write_b128 v7, v[212:215] offset:8192
  ds_write_b128 v7, v[216:219] offset:9216
  ds_write_b128 v7, v[220:223] offset:10240
  ds_write_b128 v7, v[224:227] offset:11264
  ds_write_b128 v7, v[228:231] offset:12288
  ds_write_b128 v7, v[232:235] offset:13312
  ds_write_b128 v7, v[236:239] offset:14336
  ds_write_b128 v7, v[240:243] offset:15360
  v_lshlrev_b32 v48, 16, v248
  v_and_b32 v49, 0xffff0000, v248
  v_lshlrev_b32 v50, 16, v249
  v_and_b32 v51, 0xffff0000, v249
  v_lshlrev_b32 v52, 16, v250
  v_and_b32 v53, 0xffff0000, v250
  v_lshlrev_b32 v54, 16, v251
  v_and_b32 v55, 0xffff0000, v251
  v_lshlrev_b32 v56, 16, v252
  v_and_b32 v57, 0xffff0000, v252
  v_lshlrev_b32 v58, 16, v253
  v_and_b32 v59, 0xffff0000, v253
  v_lshlrev_b32 v60, 16, v254
  v_and_b32 v61, 0xffff0000, v254
  v_lshlrev_b32 v62, 16, v255
  v_and_b32 v63, 0xffff0000, v255
  s_waitcnt lgkmcnt(0)
  s_lshl_b32 s90, s48, 2
  s_add_u32 s90, s90, 1
  v_lshlrev_b32 v4, 2, v0
  s_mov_b32 s91, 262144
  s_cmp_eq_u32 s51, 0
  s_cbranch_scc0 L_pdone_95
L_poll_94:
  buffer_load_dword v5, v4, s[8:11], s49 offen sc1
  s_waitcnt vmcnt(0)
  v_cmp_gt_u32 vcc, s90, v5
  s_cbranch_vccz L_pdone_95
  s_sleep 1
  s_sub_u32 s91, s91, 1
  s_cbranch_scc0 L_poll_94
  s_mov_b32 s51, 1
L_pdone_95:
  s_lshl_b32 s56, s44, 2
  s_lshr_b32 s53, s45, 3
  s_lshl_b32 s53, s53, 1
  s_add_u32 s56, s56, s53
  s_and_b32 s53, s46, 1
  s_add_u32 s56, s56, s53
  s_lshr_b32 s55, s46, 1
  s_lshl_b32 s54, s55, 4
  s_mul_i32 s61, s56, 32768
  s_add_u32 s61, s61, 5242880
  s_lshl_b32 s59, s54, 10
  s_add_u32 s61, s61, s59
  buffer_load_dwordx4 v[64:67], v1, s[8:11], s61 offen offset:0 sc1
  buffer_load_dwordx4 v[68:71], v1, s[8:11], s61 offen offset:1024 sc1
  buffer_load_dwordx4 v[72:75], v1, s[8:11], s61 offen offset:2048 sc1
  buffer_load_dwordx4 v[76:79], v1, s[8:11], s61 offen offset:3072 sc1
  s_add_u32 s61, s61, 4096
  buffer_load_dwordx4 v[80:83], v1, s[8:11], s61 offen offset:0 sc1
  buffer_load_dwordx4 v[84:87], v1, s[8:11], s61 offen offset:1024 sc1
  buffer_load_dwordx4 v[88:91], v1, s[8:11], s61 offen offset:2048 sc1
  buffer_load_dwordx4 v[92:95], v1, s[8:11], s61 offen offset:3072 sc1
  s_lshl_b32 s60, s55, 15
  s_add_u32 s60, s60, 65536
  v_lshrrev_b32 v4, 5, v0
  v_lshlrev_b32 v4, 2, v4
  v_bfe_u32 v6, v0, 2, 2
  v_add_u32 v4, v4, v6
  v_bfe_u32 v5, v0, 4, 1
  v_lshlrev_b32 v5, 5, v5
  v_and_b32 v6, 3, v0
  v_lshlrev_b32 v6, 3, v6
  v_add_u32 v5, v5, v6
  v_bfe_u32 v6, v4, 1, 1
  v_lshl_add_u32 v5, v4, 7, v5
  s_lshr_b32 s55, s46, 1
  v_xor_b32 v6, s55, v6
  v_lshl_add_u32 v4, v6, 6, v5
  v_xor_b32 v6, 1, v6
  v_lshl_add_u32 v5, v6, 6, v5
  v_add_u32 v4, s60, v4
  v_add_u32 v5, s60, v5
  ds_read_b64_tr_b16 v[128:129], v4 offset:0
  ds_read_b64_tr_b16 v[130:131], v4 offset:1024
  ds_read_b64_tr_b16 v[132:133], v5 offset:0
  ds_read_b64_tr_b16 v[134:135], v5 offset:1024
  ds_read_b64_tr_b16 v[136:137], v4 offset:2048
  ds_read_b64_tr_b16 v[138:139], v4 offset:3072
  ds_read_b64_tr_b16 v[140:141], v5 offset:2048
  ds_read_b64_tr_b16 v[142:143], v5 offset:3072
  s_waitcnt vmcnt(7)
  s_add_u32 s61, s61, 4096
  buffer_load_dwordx4 v[96:99], v1, s[8:11], s61 offen offset:0 sc1
  ds_read_b64_tr_b16 v[144:145], v4 offset:4096
  ds_read_b64_tr_b16 v[146:147], v4 offset:5120
  ds_read_b64_tr_b16 v[148:149], v5 offset:4096
  ds_read_b64_tr_b16 v[150:151], v5 offset:5120
  s_waitcnt lgkmcnt(8)
  v_mfma_f32_32x32x16_bf16 v[16:31], v[128:131], v[64:67], v[48:63]
  v_mfma_f32_32x32x16_bf16 v[32:47], v[132:135], v[64:67], 0
  s_waitcnt vmcnt(7)
  buffer_load_dwordx4 v[100:103], v1, s[8:11], s61 offen offset:1024 sc1
  ds_read_b64_tr_b16 v[128:129], v4 offset:6144
  ds_read_b64_tr_b16 v[130:131], v4 offset:7168
  ds_read_b64_tr_b16 v[132:133], v5 offset:6144
  ds_read_b64_tr_b16 v[134:135], v5 offset:7168
  s_waitcnt lgkmcnt(8)
  v_mfma_f32_32x32x16_bf16 v[16:31], v[136:139], v[68:71], v[16:31]
  v_mfma_f32_32x32x16_bf16 v[32:47], v[140:143], v[68:71], v[32:47]
  s_waitcnt vmcnt(7)
  buffer_load_dwordx4 v[104:107], v1, s[8:11], s61 offen offset:2048 sc1
  ds_read_b64_tr_b16 v[136:137], v4 offset:8192
  ds_read_b64_tr_b16 v[138:139], v4 offset:9216
  ds_read_b64_tr_b16 v[140:141], v5 offset:8192
  ds_read_b64_tr_b16 v[142:143], v5 offset:9216
  s_waitcnt lgkmcnt(8)
  v_mfma_f32_32x32x16_bf16 v[16:31], v[144:147], v[72:75], v[16:31]
  v_mfma_f32_32x32x16_bf16 v[32:47], v[148:151], v[72:75], v[32:47]
  s_waitcnt vmcnt(7)
  buffer_load_dwordx4 v[108:111], v1, s[8:11], s61 offen offset:3072 sc1
  ds_read_b64_tr_b16 v[144:145], v4 offset:10240
  ds_read_b64_tr_b16 v[146:147], v4 offset:11264
  ds_read_b64_tr_b16 v[148:149], v5 offset:10240
  ds_read_b64_tr_b16 v[150:151], v5 offset:11264
  s_waitcnt lgkmcnt(8)
  v_mfma_f32_32x32x16_bf16 v[16:31], v[128:131], v[76:79], v[16:31]
  v_mfma_f32_32x32x16_bf16 v[32:47], v[132:135], v[76:79], v[32:47]
  s_waitcnt vmcnt(7)
  s_add_u32 s61, s61, 4096
  buffer_load_dwordx4 v[112:115], v1, s[8:11], s61 offen offset:0 sc1
  ds_read_b64_tr_b16 v[128:129], v4 offset:12288
  ds_read_b64_tr_b16 v[130:131], v4 offset:13312
  ds_read_b64_tr_b16 v[132:133], v5 offset:12288
  ds_read_b64_tr_b16 v[134:135], v5 offset:13312
  s_waitcnt lgkmcnt(8)
  v_mfma_f32_32x32x16_bf16 v[16:31], v[136:139], v[80:83], v[16:31]
  v_mfma_f32_32x32x16_bf16 v[32:47], v[140:143], v[80:83], v[32:47]
  s_waitcnt vmcnt(7)
  buffer_load_dwordx4 v[116:119], v1, s[8:11], s61 offen offset:1024 sc1
  ds_read_b64_tr_b16 v[136:137], v4 offset:14336
  ds_read_b64_tr_b16 v[138:139], v4 offset:15360
  ds_read_b64_tr_b16 v[140:141], v5 offset:14336
  ds_read_b64_tr_b16 v[142:143], v5 offset:15360
  s_waitcnt lgkmcnt(8)
  v_mfma_f32_32x32x16_bf16 v[16:31], v[144:147], v[84:87], v[16:31]
  v_mfma_f32_32x32x16_bf16 v[32:47], v[148:151], v[84:87], v[32:47]
  s_waitcnt vmcnt(7)
  buffer_load_dwordx4 v[120:123], v1, s[8:11], s61 offen offset:2048 sc1
  ds_read_b64_tr_b16 v[144:145], v4 offset:16384
  ds_read_b64_tr_b16 v[146:147], v4 offset:17408
  ds_read_b64_tr_b16 v[148:149], v5 offset:16384
  ds_read_b64_tr_b16 v[150:151], v5 offset:17408
  s_waitcnt lgkmcnt(8)
  v_mfma_f32_32x32x16_bf16 v[16:31], v[128:131], v[88:91], v[16:31]
  v_mfma_f32_32x32x16_bf16 v[32:47], v[132:135], v[88:91], v[32:47]
  s_waitcnt vmcnt(7)
  buffer_load_dwordx4 v[124:127], v1, s[8:11], s61 offen offset:3072 sc1
  ds_read_b64_tr_b16 v[128:129], v4 offset:18432
  ds_read_b64_tr_b16 v[130:131], v4 offset:19456
  ds_read_b64_tr_b16 v[132:133], v5 offset:18432
  ds_read_b64_tr_b16 v[134:135], v5 offset:19456
  s_waitcnt lgkmcnt(8)
  v_mfma_f32_32x32x16_bf16 v[16:31], v[136:139], v[92:95], v[16:31]
  v_mfma_f32_32x32x16_bf16 v[32:47], v[140:143], v[92:95], v[32:47]
  s_waitcnt vmcnt(7)
  ds_read_b64_tr_b16 v[136:137], v4 offset:20480
  ds_read_b64_tr_b16 v[138:139], v4 offset:21504
  ds_read_b64_tr_b16 v[140:141], v5 offset:20480
  ds_read_b64_tr_b16 v[142:143], v5 offset:21504
  s_waitcnt lgkmcnt(8)
  v_mfma_f32_32x32x16_bf16 v[16:31], v[144:147], v[96:99], v[16:31]
  v_mfma_f32_32x32x16_bf16 v[32:47], v[148:151], v[96:99], v[32:47]
  s_waitcnt vmcnt(6)
  ds_read_b64_tr_b16 v[144:145], v4 offset:22528
  ds_read_b64_tr_b16 v[146:147], v4 offset:23552
  ds_read_b64_tr_b16 v[148:149], v5 offset:22528
  ds_read_b64_tr_b16 v[150:151], v5 offset:23552
  s_waitcnt lgkmcnt(8)
  v_mfma_f32_32x32x16_bf16 v[16:31], v[128:131], v[100:103], v[16:31]
  v_mfma_f32_32x32x16_bf16 v[32:47], v[132:135], v[100:103], v[32:47]
  s_waitcnt vmcnt(5)
  ds_read_b64_tr_b16 v[128:129], v4 offset:24576
  ds_read_b64_tr_b16 v[130:131], v4 offset:25600
  ds_read_b64_tr_b16 v[132:133], v5 offset:24576
  ds_read_b64_tr_b16 v[134:135], v5 offset:25600
  s_waitcnt lgkmcnt(8)
  v_mfma_f32_32x32x16_bf16 v[16:31], v[136:139], v[104:107], v[16:31]
  v_mfma_f32_32x32x16_bf16 v[32:47], v[140:143], v[104:107], v[32:47]
  s_waitcnt vmcnt(4)
  ds_read_b64_tr_b16 v[136:137], v4 offset:26624
  ds_read_b64_tr_b16 v[138:139], v4 offset:27648
  ds_read_b64_tr_b16 v[140:141], v5 offset:26624
  ds_read_b64_tr_b16 v[142:143], v5 offset:27648
  s_waitcnt lgkmcnt(8)
  v_mfma_f32_32x32x16_bf16 v[16:31], v[144:147], v[108:111], v[16:31]
  v_mfma_f32_32x32x16_bf16 v[32:47], v[148:151], v[108:111], v[32:47]
  s_waitcnt vmcnt(3)
  ds_read_b64_tr_b16 v[144:145], v4 offset:28672
  ds_read_b64_tr_b16 v[146:147], v4 offset:29696
  ds_read_b64_tr_b16 v[148:149], v5 offset:28672
  ds_read_b64_tr_b16 v[150:151], v5 offset:29696
  s_waitcnt lgkmcnt(8)
  v_mfma_f32_32x32x16_bf16 v[16:31], v[128:131], v[112:115], v[16:31]
  v_mfma_f32_32x32x16_bf16 v[32:47], v[132:135], v[112:115], v[32:47]
  s_waitcnt vmcnt(2)
  ds_read_b64_tr_b16 v[128:129], v4 offset:30720
  ds_read_b64_tr_b16 v[130:131], v4 offset:31744
  ds_read_b64_tr_b16 v[132:133], v5 offset:30720
  ds_read_b64_tr_b16 v[134:135], v5 offset:31744
  s_waitcnt lgkmcnt(8)
  v_mfma_f32_32x32x16_bf16 v[16:31], v[136:139], v[116:119], v[16:31]
  v_mfma_f32_32x32x16_bf16 v[32:47], v[140:143], v[116:119], v[32:47]
  s_waitcnt vmcnt(1)
  s_waitcnt lgkmcnt(4)
  v_mfma_f32_32x32x16_bf16 v[16:31], v[144:147], v[120:123], v[16:31]
  v_mfma_f32_32x32x16_bf16 v[32:47], v[148:151], v[120:123], v[32:47]
  s_waitcnt vmcnt(0)
  s_waitcnt lgkmcnt(0)
  v_mfma_f32_32x32x16_bf16 v[16:31], v[128:131], v[124:127], v[16:31]
  v_mfma_f32_32x32x16_bf16 v[32:47], v[132:135], v[124:127], v[32:47]
  s_nop 11
  s_lshl_b32 s52, s46, 12
  s_add_u32 s52, s52, 131072
  v_add_u32 v6, s52, v1
  ds_write_b128 v6, v[32:35] offset:0
  ds_write_b128 v6, v[36:39] offset:1024
  ds_write_b128 v6, v[40:43] offset:2048
  ds_write_b128 v6, v[44:47] offset:3072
  s_lshl_b32 s56, s44, 2
  s_lshr_b32 s53, s45, 3
  s_lshl_b32 s53, s53, 1
  s_add_u32 s56, s56, s53
  s_and_b32 s53, s46, 1
  s_add_u32 s56, s56, s53
  s_lshr_b32 s55, s46, 1
  s_lshl_b32 s52, s56, 15
  s_and_b32 s53, s45, 7
  s_lshl_b32 s54, s53, 12
  s_add_u32 s52, s52, s54
  s_lshl_b32 s54, s55, 11
  s_add_u32 s52, s52, s54
  s_add_u32 s52, s52, 3145728
  s_lshl_b32 s57, s56, 12
  s_lshl_b32 s54, s53, 9
  s_add_u32 s57, s57, s54
  s_lshl_b32 s54, s55, 8
  s_add_u32 s57, s57, s54
  s_add_u32 s57, s57, 7602176
  s_xor_b32 s58, s46, 2
  s_lshl_b32 s58, s58, 12
  s_add_u32 s58, s58, 131072
  v_add_u32 v7, s58, v1
  v_and_b32 v10, 31, v0
  v_lshlrev_b32 v10, 3, v10
  s_waitcnt lgkmcnt(0)
  s_barrier
  ds_read_b128 v[32:35], v7 offset:0
  ds_read_b128 v[36:39], v7 offset:1024
  ds_read_b128 v[40:43], v7 offset:2048
  ds_read_b128 v[44:47], v7 offset:3072
  s_waitcnt lgkmcnt(3)
  v_pk_add_f32 v[16:17], v[16:17], v[32:33]
  v_pk_add_f32 v[18:19], v[18:19], v[34:35]
  s_waitcnt lgkmcnt(2)
  v_pk_add_f32 v[20:21], v[20:21], v[36:37]
  v_pk_add_f32 v[22:23], v[22:23], v[38:39]
  s_waitcnt lgkmcnt(1)
  v_pk_add_f32 v[24:25], v[24:25], v[40:41]
  v_pk_add_f32 v[26:27], v[26:27], v[42:43]
  s_waitcnt lgkmcnt(0)
  v_pk_add_f32 v[28:29], v[28:29], v[44:45]
  v_pk_add_f32 v[30:31], v[30:31], v[46:47]
  v_cvt_pk_bf16_f32 v248, v16, v17
  v_cvt_pk_bf16_f32 v249, v18, v19
  v_cvt_pk_bf16_f32 v250, v20, v21
  v_cvt_pk_bf16_f32 v251, v22, v23
  v_cvt_pk_bf16_f32 v252, v24, v25
  v_cvt_pk_bf16_f32 v253, v26, v27
  v_cvt_pk_bf16_f32 v254, v28, v29
  v_cvt_pk_bf16_f32 v255, v30, v31
  s_cmp_eq_u32 s47, 1
  s_cbranch_scc1 L_fast_96
  buffer_store_dwordx4 v[248:251], v1, s[8:11], s52 offen sc1
  buffer_store_dwordx4 v[252:255], v1, s[8:11], s52 offen offset:1024 sc1
  s_branch L_join_97
L_fast_96:
  buffer_store_dwordx4 v[248:251], v1, s[8:11], s52 offen
  buffer_store_dwordx4 v[252:255], v1, s[8:11], s52 offen offset:1024
L_join_97:
  v_pk_mul_f32 v[32:33], v[16:17], v[16:17]
  v_pk_add_f32 v[34:35], v[16:17], v[18:19]
  v_pk_fma_f32 v[32:33], v[18:19], v[18:19], v[32:33]
  v_pk_add_f32 v[34:35], v[34:35], v[20:21]
  v_pk_fma_f32 v[32:33], v[20:21], v[20:21], v[32:33]
  v_pk_add_f32 v[34:35], v[34:35], v[22:23]
  v_pk_fma_f32 v[32:33], v[22:23], v[22:23], v[32:33]
  v_pk_add_f32 v[34:35], v[34:35], v[24:25]
  v_pk_fma_f32 v[32:33], v[24:25], v[24:25], v[32:33]
  v_pk_add_f32 v[34:35], v[34:35], v[26:27]
  v_pk_fma_f32 v[32:33], v[26:27], v[26:27], v[32:33]
  v_pk_add_f32 v[34:35], v[34:35], v[28:29]
  v_pk_fma_f32 v[32:33], v[28:29], v[28:29], v[32:33]
  v_pk_add_f32 v[34:35], v[34:35], v[30:31]
  v_pk_fma_f32 v[32:33], v[30:31], v[30:31], v[32:33]
  v_add_f32 v8, v34, v35
  v_add_f32 v9, v32, v33
  v_mov_b32 v12, v8
  v_mov_b32 v13, v9
  s_nop 1
  v_permlane32_swap_b32 v12, v8
  v_permlane32_swap_b32 v13, v9
  s_nop 0
  v_pk_add_f32 v[8:9], v[8:9], v[12:13]
  s_cmp_eq_u32 s47, 1
  s_cbranch_scc1 L_fast_98
  s_mov_b64 exec, s[88:89]
  buffer_store_dwordx2 v[8:9], v10, s[8:11], s57 offen sc1
  s_mov_b64 exec, -1
  s_branch L_join_99
L_fast_98:
  s_mov_b64 exec, s[88:89]
  buffer_store_dwordx2 v[8:9], v10, s[8:11], s57 offen
  s_mov_b64 exec, -1
L_join_99:
  s_waitcnt vmcnt(0)
  s_lshl_b32 s52, s48, 2
  s_add_u32 s52, s52, 2
  v_mov_b32 v4, s52
  v_mov_b32 v5, 0
  s_mov_b64 exec, 1
  s_cmp_eq_u32 s47, 1
  s_cbranch_scc1 L_fast_100
  buffer_store_dword v4, v5, s[8:11], s50 offen sc1
  s_branch L_join_101
L_fast_100:
  buffer_store_dword v4, v5, s[8:11], s50 offen
L_join_101:
  s_mov_b64 exec, -1
  s_branch L_p4_compute
L_p3_helper:
  s_barrier
  s_lshl_b32 s52, s46, 14
  v_add_u32 v6, s52, v1
  ds_write_b128 v6, v[180:183] offset:0
  ds_write_b128 v6, v[184:187] offset:1024
  ds_write_b128 v6, v[188:191] offset:2048
  ds_write_b128 v6, v[192:195] offset:3072
  ds_write_b128 v6, v[196:199] offset:4096
  ds_write_b128 v6, v[200:203] offset:5120
  ds_write_b128 v6, v[204:207] offset:6144
  ds_write_b128 v6, v[208:211] offset:7168
  ds_write_b128 v6, v[212:215] offset:8192
  ds_write_b128 v6, v[216:219] offset:9216
  ds_write_b128 v6, v[220:223] offset:10240
  ds_write_b128 v6, v[224:227] offset:11264
  ds_write_b128 v6, v[228:231] offset:12288
  ds_write_b128 v6, v[232:235] offset:13312
  ds_write_b128 v6, v[236:239] offset:14336
  ds_write_b128 v6, v[240:243] offset:15360
  s_sub_u32 s52, s46, 4
  s_lshr_b32 s53, s52, 1
  s_and_b32 s54, s52, 1
  s_mul_i32 s60, s53, 114688
  s_lshl_b32 s56, s54, 13
  s_add_u32 s60, s60, s56
  s_and_b32 s56, s45, 7
  s_mul_i32 s56, s56, 229376
  s_add_u32 s60, s60, s56
  s_add_u32 s60, s60, 30408704
  s_waitcnt lgkmcnt(0)
  s_barrier
  s_cmp_lg_u32 s48, 0
  s_cbranch_scc1 L_cs4_102
  v_lshrrev_b32 v4, 5, v0
  v_lshlrev_b32 v4, 2, v4
  v_bfe_u32 v6, v0, 2, 2
  v_add_u32 v4, v4, v6
  v_bfe_u32 v5, v0, 4, 1
  v_lshlrev_b32 v5, 5, v5
  v_and_b32 v6, 3, v0
  v_lshlrev_b32 v6, 3, v6
  v_add_u32 v5, v5, v6
  s_sub_u32 s52, s46, 4
  v_and_b32 v6, 3, v4
  v_xor_b32 v6, s52, v6
  v_lshl_add_u32 v5, v6, 6, v5
  v_lshl_add_u32 v4, v4, 8, v5
  v_mov_b32 v8, 0x3f803f80
  v_mov_b32 v9, 0x3f803f80
  v_mov_b32 v10, 0x3f803f80
  v_mov_b32 v11, 0x3f803f80
  ds_read_b64_tr_b16 v[208:209], v4 offset:0
  ds_read_b64_tr_b16 v[210:211], v4 offset:2048
  ds_read_b64_tr_b16 v[212:213], v4 offset:4096
  ds_read_b64_tr_b16 v[214:215], v4 offset:6144
  ds_read_b64_tr_b16 v[216:217], v4 offset:8192
  ds_read_b64_tr_b16 v[218:219], v4 offset:10240
  ds_read_b64_tr_b16 v[220:221], v4 offset:12288
  ds_read_b64_tr_b16 v[222:223], v4 offset:14336
  ds_read_b64_tr_b16 v[224:225], v4 offset:16384
  ds_read_b64_tr_b16 v[226:227], v4 offset:18432
  ds_read_b64_tr_b16 v[228:229], v4 offset:20480
  ds_read_b64_tr_b16 v[230:231], v4 offset:22528
  ds_read_b64_tr_b16 v[232:233], v4 offset:24576
  ds_read_b64_tr_b16 v[234:235], v4 offset:26624
  ds_read_b64_tr_b16 v[236:237], v4 offset:28672
  ds_read_b64_tr_b16 v[238:239], v4 offset:30720
  v_add_u32 v4, 32768, v4
  buffer_load_dwordx4 v[16:19], v1, s[8:11], s60 offen offset:0 sc1
  s_sleep 1
  s_waitcnt lgkmcnt(14)
  v_mfma_f32_32x32x16_bf16 v[240:255], v[208:211], v[8:11], 0
  buffer_load_dwordx4 v[20:23], v1, s[8:11], s60 offen offset:1024 sc1
  s_sleep 1
  s_waitcnt lgkmcnt(12)
  v_mfma_f32_32x32x16_bf16 v[240:255], v[212:215], v[8:11], v[240:255]
  buffer_load_dwordx4 v[24:27], v1, s[8:11], s60 offen offset:2048 sc1
  s_sleep 1
  s_waitcnt lgkmcnt(10)
  v_mfma_f32_32x32x16_bf16 v[240:255], v[216:219], v[8:11], v[240:255]
  buffer_load_dwordx4 v[28:31], v1, s[8:11], s60 offen offset:3072 sc1
  s_add_u32 s60, s60, 4096
  s_sleep 1
  s_waitcnt lgkmcnt(8)
  v_mfma_f32_32x32x16_bf16 v[240:255], v[220:223], v[8:11], v[240:255]
  buffer_load_dwordx4 v[32:35], v1, s[8:11], s60 offen offset:0 sc1
  s_sleep 1
  s_waitcnt lgkmcnt(6)
  v_mfma_f32_32x32x16_bf16 v[240:255], v[224:227], v[8:11], v[240:255]
  buffer_load_dwordx4 v[36:39], v1, s[8:11], s60 offen offset:1024 sc1
  s_sleep 1
  s_waitcnt lgkmcnt(4)
  v_mfma_f32_32x32x16_bf16 v[240:255], v[228:231], v[8:11], v[240:255]
  buffer_load_dwordx4 v[40:43], v1, s[8:11], s60 offen offset:2048 sc1
  s_sleep 1
  s_waitcnt lgkmcnt(2)
  v_mfma_f32_32x32x16_bf16 v[240:255], v[232:235], v[8:11], v[240:255]
  buffer_load_dwordx4 v[44:47], v1, s[8:11], s60 offen offset:3072 sc1
  s_add_u32 s60, s60, 12288
  s_sleep 1
  s_waitcnt lgkmcnt(0)
  v_mfma_f32_32x32x16_bf16 v[240:255], v[236:239], v[8:11], v[240:255]
  ds_read_b64_tr_b16 v[208:209], v4 offset:0
  ds_read_b64_tr_b16 v[210:211], v4 offset:2048
  ds_read_b64_tr_b16 v[212:213], v4 offset:4096
  ds_read_b64_tr_b16 v[214:215], v4 offset:6144
  ds_read_b64_tr_b16 v[216:217], v4 offset:8192
  ds_read_b64_tr_b16 v[218:219], v4 offset:10240
  ds_read_b64_tr_b16 v[220:221], v4 offset:12288
  ds_read_b64_tr_b16 v[222:223], v4 offset:14336
  ds_read_b64_tr_b16 v[224:225], v4 offset:16384
  ds_read_b64_tr_b16 v[226:227], v4 offset:18432
  ds_read_b64_tr_b16 v[228:229], v4 offset:20480
  ds_read_b64_tr_b16 v[230:231], v4 offset:22528
  ds_read_b64_tr_b16 v[232:233], v4 offset:24576
  ds_read_b64_tr_b16 v[234:235], v4 offset:26624
  ds_read_b64_tr_b16 v[236:237], v4 offset:28672
  ds_read_b64_tr_b16 v[238:239], v4 offset:30720
  v_add_u32 v4, 32768, v4
  buffer_load_dwordx4 v[48:51], v1, s[8:11], s60 offen offset:0 sc1
  s_sleep 1
  s_waitcnt lgkmcnt(14)
  v_mfma_f32_32x32x16_bf16 v[240:255], v[208:211], v[8:11], v[240:255]
  buffer_load_dwordx4 v[52:55], v1, s[8:11], s60 offen offset:1024 sc1
  s_sleep 1
  s_waitcnt lgkmcnt(12)
  v_mfma_f32_32x32x16_bf16 v[240:255], v[212:215], v[8:11], v[240:255]
  buffer_load_dwordx4 v[56:59], v1, s[8:11], s60 offen offset:2048 sc1
  s_sleep 1
  s_waitcnt lgkmcnt(10)
  v_mfma_f32_32x32x16_bf16 v[240:255], v[216:219], v[8:11], v[240:255]
  buffer_load_dwordx4 v[60:63], v1, s[8:11], s60 offen offset:3072 sc1
  s_add_u32 s60, s60, 4096
  s_sleep 1
  s_waitcnt lgkmcnt(8)
  v_mfma_f32_32x32x16_bf16 v[240:255], v[220:223], v[8:11], v[240:255]
  buffer_load_dwordx4 v[64:67], v1, s[8:11], s60 offen offset:0 sc1
  s_sleep 1
  s_waitcnt lgkmcnt(6)
  v_mfma_f32_32x32x16_bf16 v[240:255], v[224:227], v[8:11], v[240:255]
  buffer_load_dwordx4 v[68:71], v1, s[8:11], s60 offen offset:1024 sc1
  s_sleep 1
  s_waitcnt lgkmcnt(4)
  v_mfma_f32_32x32x16_bf16 v[240:255], v[228:231], v[8:11], v[240:255]
  buffer_load_dwordx4 v[72:75], v1, s[8:11], s60 offen offset:2048 sc1
  s_sleep 1
  s_waitcnt lgkmcnt(2)
  v_mfma_f32_32x32x16_bf16 v[240:255], v[232:235], v[8:11], v[240:255]
  buffer_load_dwordx4 v[76:79], v1, s[8:11], s60 offen offset:3072 sc1
  s_add_u32 s60, s60, 12288
  s_sleep 1
  s_waitcnt lgkmcnt(0)
  v_mfma_f32_32x32x16_bf16 v[240:255], v[236:239], v[8:11], v[240:255]
  ds_read_b64_tr_b16 v[208:209], v4 offset:0
  ds_read_b64_tr_b16 v[210:211], v4 offset:2048
  ds_read_b64_tr_b16 v[212:213], v4 offset:4096
  ds_read_b64_tr_b16 v[214:215], v4 offset:6144
  ds_read_b64_tr_b16 v[216:217], v4 offset:8192
  ds_read_b64_tr_b16 v[218:219], v4 offset:10240
  ds_read_b64_tr_b16 v[220:221], v4 offset:12288
  ds_read_b64_tr_b16 v[222:223], v4 offset:14336
  ds_read_b64_tr_b16 v[224:225], v4 offset:16384
  ds_read_b64_tr_b16 v[226:227], v4 offset:18432
  ds_read_b64_tr_b16 v[228:229], v4 offset:20480
  ds_read_b64_tr_b16 v[230:231], v4 offset:22528
  ds_read_b64_tr_b16 v[232:233], v4 offset:24576
  ds_read_b64_tr_b16 v[234:235], v4 offset:26624
  ds_read_b64_tr_b16 v[236:237], v4 offset:28672
  ds_read_b64_tr_b16 v[238:239], v4 offset:30720
  v_add_u32 v4, 32768, v4
  buffer_load_dwordx4 v[80:83], v1, s[8:11], s60 offen offset:0 sc1
  s_sleep 1
  s_waitcnt lgkmcnt(14)
  v_mfma_f32_32x32x16_bf16 v[240:255], v[208:211], v[8:11], v[240:255]
  buffer_load_dwordx4 v[84:87], v1, s[8:11], s60 offen offset:1024 sc1
  s_sleep 1
  s_waitcnt lgkmcnt(12)
  v_mfma_f32_32x32x16_bf16 v[240:255], v[212:215], v[8:11], v[240:255]
  buffer_load_dwordx4 v[88:91], v1, s[8:11], s60 offen offset:2048 sc1
  s_sleep 1
  s_waitcnt lgkmcnt(10)
  v_mfma_f32_32x32x16_bf16 v[240:255], v[216:219], v[8:11], v[240:255]
  buffer_load_dwordx4 v[92:95], v1, s[8:11], s60 offen offset:3072 sc1
  s_add_u32 s60, s60, 4096
  s_sleep 1
  s_waitcnt lgkmcnt(8)
  v_mfma_f32_32x32x16_bf16 v[240:255], v[220:223], v[8:11], v[240:255]
  buffer_load_dwordx4 v[96:99], v1, s[8:11], s60 offen offset:0 sc1
  s_sleep 1
  s_waitcnt lgkmcnt(6)
  v_mfma_f32_32x32x16_bf16 v[240:255], v[224:227], v[8:11], v[240:255]
  buffer_load_dwordx4 v[100:103], v1, s[8:11], s60 offen offset:1024 sc1
  s_sleep 1
  s_waitcnt lgkmcnt(4)
  v_mfma_f32_32x32x16_bf16 v[240:255], v[228:231], v[8:11], v[240:255]
  buffer_load_dwordx4 v[104:107], v1, s[8:11], s60 offen offset:2048 sc1
  s_sleep 1
  s_waitcnt lgkmcnt(2)
  v_mfma_f32_32x32x16_bf16 v[240:255], v[232:235], v[8:11], v[240:255]
  buffer_load_dwordx4 v[108:111], v1, s[8:11], s60 offen offset:3072 sc1
  s_add_u32 s60, s60, 12288
  s_sleep 1
  s_waitcnt lgkmcnt(0)
  v_mfma_f32_32x32x16_bf16 v[240:255], v[236:239], v[8:11], v[240:255]
  ds_read_b64_tr_b16 v[208:209], v4 offset:0
  ds_read_b64_tr_b16 v[210:211], v4 offset:2048
  ds_read_b64_tr_b16 v[212:213], v4 offset:4096
  ds_read_b64_tr_b16 v[214:215], v4 offset:6144
  ds_read_b64_tr_b16 v[216:217], v4 offset:8192
  ds_read_b64_tr_b16 v[218:219], v4 offset:10240
  ds_read_b64_tr_b16 v[220:221], v4 offset:12288
  ds_read_b64_tr_b16 v[222:223], v4 offset:14336
  ds_read_b64_tr_b16 v[224:225], v4 offset:16384
  ds_read_b64_tr_b16 v[226:227], v4 offset:18432
  ds_read_b64_tr_b16 v[228:229], v4 offset:20480
  ds_read_b64_tr_b16 v[230:231], v4 offset:22528
  ds_read_b64_tr_b16 v[232:233], v4 offset:24576
  ds_read_b64_tr_b16 v[234:235], v4 offset:26624
  ds_read_b64_tr_b16 v[236:237], v4 offset:28672
  ds_read_b64_tr_b16 v[238:239], v4 offset:30720
  v_add_u32 v4, 32768, v4
  buffer_load_dwordx4 v[112:115], v1, s[8:11], s60 offen offset:0 sc1
  s_sleep 1
  s_waitcnt lgkmcnt(14)
  v_mfma_f32_32x32x16_bf16 v[240:255], v[208:211], v[8:11], v[240:255]
  buffer_load_dwordx4 v[116:119], v1, s[8:11], s60 offen offset:1024 sc1
  s_sleep 1
  s_waitcnt lgkmcnt(12)
  v_mfma_f32_32x32x16_bf16 v[240:255], v[212:215], v[8:11], v[240:255]
  buffer_load_dwordx4 v[120:123], v1, s[8:11], s60 offen offset:2048 sc1
  s_sleep 1
  s_waitcnt lgkmcnt(10)
  v_mfma_f32_32x32x16_bf16 v[240:255], v[216:219], v[8:11], v[240:255]
  buffer_load_dwordx4 v[124:127], v1, s[8:11], s60 offen offset:3072 sc1
  s_add_u32 s60, s60, 4096
  s_sleep 1
  s_waitcnt lgkmcnt(8)
  v_mfma_f32_32x32x16_bf16 v[240:255], v[220:223], v[8:11], v[240:255]
  buffer_load_dwordx4 v[128:131], v1, s[8:11], s60 offen offset:0 sc1
  s_sleep 1
  s_waitcnt lgkmcnt(6)
  v_mfma_f32_32x32x16_bf16 v[240:255], v[224:227], v[8:11], v[240:255]
  buffer_load_dwordx4 v[132:135], v1, s[8:11], s60 offen offset:1024 sc1
  s_sleep 1
  s_waitcnt lgkmcnt(4)
  v_mfma_f32_32x32x16_bf16 v[240:255], v[228:231], v[8:11], v[240:255]
  buffer_load_dwordx4 v[136:139], v1, s[8:11], s60 offen offset:2048 sc1
  s_sleep 1
  s_waitcnt lgkmcnt(2)
  v_mfma_f32_32x32x16_bf16 v[240:255], v[232:235], v[8:11], v[240:255]
  buffer_load_dwordx4 v[140:143], v1, s[8:11], s60 offen offset:3072 sc1
  s_add_u32 s60, s60, 12288
  s_sleep 1
  s_waitcnt lgkmcnt(0)
  v_mfma_f32_32x32x16_bf16 v[240:255], v[236:239], v[8:11], v[240:255]
  s_nop 13
  s_sub_u32 s52, s46, 4
  s_lshl_b32 s53, s52, 7
  s_add_u32 s53, s53, 162304
  v_lshrrev_b32 v10, 5, v0
  v_lshl_add_u32 v10, v10, 4, s53
  s_mov_b32 s54, 1
  s_mov_b32 s55, 1
  s_mov_b64 exec, s[54:55]
  ds_write_b128 v10, v[240:243] offset:0
  ds_write_b128 v10, v[244:247] offset:32
  ds_write_b128 v10, v[248:251] offset:64
  ds_write_b128 v10, v[252:255] offset:96
  s_mov_b64 exec, -1
  s_waitcnt lgkmcnt(0)
  s_barrier
  buffer_load_dwordx4 v[144:147], v1, s[8:11], s60 offen offset:0 sc1
  s_sleep 1
  buffer_load_dwordx4 v[148:151], v1, s[8:11], s60 offen offset:1024 sc1
  s_sleep 1
  buffer_load_dwordx4 v[152:155], v1, s[8:11], s60 offen offset:2048 sc1
  s_sleep 1
  buffer_load_dwordx4 v[156:159], v1, s[8:11], s60 offen offset:3072 sc1
  s_add_u32 s60, s60, 4096
  s_sleep 1
  buffer_load_dwordx4 v[160:163], v1, s[8:11], s60 offen offset:0 sc1
  s_sleep 1
  buffer_load_dwordx4 v[164:167], v1, s[8:11], s60 offen offset:1024 sc1
  s_sleep 1
  buffer_load_dwordx4 v[168:171], v1, s[8:11], s60 offen offset:2048 sc1
  s_sleep 1
  buffer_load_dwordx4 v[172:175], v1, s[8:11], s60 offen offset:3072 sc1
  s_add_u32 s60, s60, 12288
  s_sleep 1
  buffer_load_dwordx4 v[176:179], v1, s[8:11], s60 offen offset:0 sc1
  s_sleep 1
  buffer_load_dwordx4 v[180:183], v1, s[8:11], s60 offen offset:1024 sc1
  s_sleep 1
  buffer_load_dwordx4 v[184:187], v1, s[8:11], s60 offen offset:2048 sc1
  s_sleep 1
  buffer_load_dwordx4 v[188:191], v1, s[8:11], s60 offen offset:3072 sc1
  s_add_u32 s60, s60, 4096
  s_sleep 1
  buffer_load_dwordx4 v[192:195], v1, s[8:11], s60 offen offset:0 sc1
  s_sleep 1
  buffer_load_dwordx4 v[196:199], v1, s[8:11], s60 offen offset:1024 sc1
  s_sleep 1
  buffer_load_dwordx4 v[200:203], v1, s[8:11], s60 offen offset:2048 sc1
  s_sleep 1
  buffer_load_dwordx4 v[204:207], v1, s[8:11], s60 offen offset:3072 sc1
  s_add_u32 s60, s60, 12288
  s_sleep 1
  buffer_load_dwordx4 v[208:211], v1, s[8:11], s60 offen offset:0 sc1
  s_sleep 1
  buffer_load_dwordx4 v[212:215], v1, s[8:11], s60 offen offset:1024 sc1
  s_sleep 1
  buffer_load_dwordx4 v[216:219], v1, s[8:11], s60 offen offset:2048 sc1
  s_sleep 1
  buffer_load_dwordx4 v[220:223], v1, s[8:11], s60 offen offset:3072 sc1
  s_add_u32 s60, s60, 4096
  s_sleep 1
  buffer_load_dwordx4 v[224:227], v1, s[8:11], s60 offen offset:0 sc1
  s_sleep 1
  buffer_load_dwordx4 v[228:231], v1, s[8:11], s60 offen offset:1024 sc1
  s_sleep 1
  buffer_load_dwordx4 v[232:235], v1, s[8:11], s60 offen offset:2048 sc1
  s_sleep 1
  buffer_load_dwordx4 v[236:239], v1, s[8:11], s60 offen offset:3072 sc1
  s_add_u32 s60, s60, 12288
  s_sleep 1
  s_branch L_w2done_103
L_cs4_102:
  buffer_load_dwordx4 v[16:19], v1, s[8:11], s60 offen offset:0 sc1
  s_sleep 2
  buffer_load_dwordx4 v[20:23], v1, s[8:11], s60 offen offset:1024 sc1
  s_sleep 2
  buffer_load_dwordx4 v[24:27], v1, s[8:11], s60 offen offset:2048 sc1
  s_sleep 2
  buffer_load_dwordx4 v[28:31], v1, s[8:11], s60 offen offset:3072 sc1
  s_add_u32 s60, s60, 4096
  s_sleep 2
  buffer_load_dwordx4 v[32:35], v1, s[8:11], s60 offen offset:0 sc1
  s_sleep 2
  buffer_load_dwordx4 v[36:39], v1, s[8:11], s60 offen offset:1024 sc1
  s_sleep 2
  buffer_load_dwordx4 v[40:43], v1, s[8:11], s60 offen offset:2048 sc1
  s_sleep 2
  buffer_load_dwordx4 v[44:47], v1, s[8:11], s60 offen offset:3072 sc1
  s_add_u32 s60, s60, 12288
  s_sleep 2
  buffer_load_dwordx4 v[48:51], v1, s[8:11], s60 offen offset:0 sc1
  s_sleep 2
  buffer_load_dwordx4 v[52:55], v1, s[8:11], s60 offen offset:1024 sc1
  s_sleep 2
  buffer_load_dwordx4 v[56:59], v1, s[8:11], s60 offen offset:2048 sc1
  s_sleep 2
  buffer_load_dwordx4 v[60:63], v1, s[8:11], s60 offen offset:3072 sc1
  s_add_u32 s60, s60, 4096
  s_sleep 2
  buffer_load_dwordx4 v[64:67], v1, s[8:11], s60 offen offset:0 sc1
  s_sleep 2
  buffer_load_dwordx4 v[68:71], v1, s[8:11], s60 offen offset:1024 sc1
  s_sleep 2
  buffer_load_dwordx4 v[72:75], v1, s[8:11], s60 offen offset:2048 sc1
  s_sleep 2
  buffer_load_dwordx4 v[76:79], v1, s[8:11], s60 offen offset:3072 sc1
  s_add_u32 s60, s60, 12288
  s_sleep 2
  buffer_load_dwordx4 v[80:83], v1, s[8:11], s60 offen offset:0 sc1
  s_sleep 2
  buffer_load_dwordx4 v[84:87], v1, s[8:11], s60 offen offset:1024 sc1
  s_sleep 2
  buffer_load_dwordx4 v[88:91], v1, s[8:11], s60 offen offset:2048 sc1
  s_sleep 2
  buffer_load_dwordx4 v[92:95], v1, s[8:11], s60 offen offset:3072 sc1
  s_add_u32 s60, s60, 4096
  s_sleep 2
  buffer_load_dwordx4 v[96:99], v1, s[8:11], s60 offen offset:0 sc1
  s_sleep 2
  buffer_load_dwordx4 v[100:103], v1, s[8:11], s60 offen offset:1024 sc1
  s_sleep 2
  buffer_load_dwordx4 v[104:107], v1, s[8:11], s60 offen offset:2048 sc1
  s_sleep 2
  buffer_load_dwordx4 v[108:111], v1, s[8:11], s60 offen offset:3072 sc1
  s_add_u32 s60, s60, 12288
  s_sleep 2
  buffer_load_dwordx4 v[112:115], v1, s[8:11], s60 offen offset:0 sc1
  s_sleep 2
  buffer_load_dwordx4 v[116:119], v1, s[8:11], s60 offen offset:1024 sc1
  s_sleep 2
  buffer_load_dwordx4 v[120:123], v1, s[8:11], s60 offen offset:2048 sc1
  s_sleep 2
  buffer_load_dwordx4 v[124:127], v1, s[8:11], s60 offen offset:3072 sc1
  s_add_u32 s60, s60, 4096
  s_sleep 2
  buffer_load_dwordx4 v[128:131], v1, s[8:11], s60 offen offset:0 sc1
  s_sleep 2
  buffer_load_dwordx4 v[132:135], v1, s[8:11], s60 offen offset:1024 sc1
  s_sleep 2
  buffer_load_dwordx4 v[136:139], v1, s[8:11], s60 offen offset:2048 sc1
  s_sleep 2
  buffer_load_dwordx4 v[140:143], v1, s[8:11], s60 offen offset:3072 sc1
  s_add_u32 s60, s60, 12288
  s_sleep 2
  buffer_load_dwordx4 v[144:147], v1, s[8:11], s60 offen offset:0 sc1
  s_sleep 1
  buffer_load_dwordx4 v[148:151], v1, s[8:11], s60 offen offset:1024 sc1
  s_sleep 1
  buffer_load_dwordx4 v[152:155], v1, s[8:11], s60 offen offset:2048 sc1
  s_sleep 1
  buffer_load_dwordx4 v[156:159], v1, s[8:11], s60 offen offset:3072 sc1
  s_add_u32 s60, s60, 4096
  s_sleep 1
  buffer_load_dwordx4 v[160:163], v1, s[8:11], s60 offen offset:0 sc1
  s_sleep 1
  buffer_load_dwordx4 v[164:167], v1, s[8:11], s60 offen offset:1024 sc1
  s_sleep 1
  buffer_load_dwordx4 v[168:171], v1, s[8:11], s60 offen offset:2048 sc1
  s_sleep 1
  buffer_load_dwordx4 v[172:175], v1, s[8:11], s60 offen offset:3072 sc1
  s_add_u32 s60, s60, 12288
  s_sleep 1
  buffer_load_dwordx4 v[176:179], v1, s[8:11], s60 offen offset:0 sc1
  s_sleep 1
  buffer_load_dwordx4 v[180:183], v1, s[8:11], s60 offen offset:1024 sc1
  s_sleep 1
  buffer_load_dwordx4 v[184:187], v1, s[8:11], s60 offen offset:2048 sc1
  s_sleep 1
  buffer_load_dwordx4 v[188:191], v1, s[8:11], s60 offen offset:3072 sc1
  s_add_u32 s60, s60, 4096
  s_sleep 1
  buffer_load_dwordx4 v[192:195], v1, s[8:11], s60 offen offset:0 sc1
  s_sleep 1
  buffer_load_dwordx4 v[196:199], v1, s[8:11], s60 offen offset:1024 sc1
  s_sleep 1
  buffer_load_dwordx4 v[200:203], v1, s[8:11], s60 offen offset:2048 sc1
  s_sleep 1
  buffer_load_dwordx4 v[204:207], v1, s[8:11], s60 offen offset:3072 sc1
  s_add_u32 s60, s60, 12288
  s_sleep 1
  buffer_load_dwordx4 v[208:211], v1, s[8:11], s60 offen offset:0 sc1
  s_sleep 1
  buffer_load_dwordx4 v[212:215], v1, s[8:11], s60 offen offset:1024 sc1
  s_sleep 1
  buffer_load_dwordx4 v[216:219], v1, s[8:11], s60 offen offset:2048 sc1
  s_sleep 1
  buffer_load_dwordx4 v[220:223], v1, s[8:11], s60 offen offset:3072 sc1
  s_add_u32 s60, s60, 4096
  s_sleep 1
  buffer_load_dwordx4 v[224:227], v1, s[8:11], s60 offen offset:0 sc1
  s_sleep 1
  buffer_load_dwordx4 v[228:231], v1, s[8:11], s60 offen offset:1024 sc1
  s_sleep 1
  buffer_load_dwordx4 v[232:235], v1, s[8:11], s60 offen offset:2048 sc1
  s_sleep 1
  buffer_load_dwordx4 v[236:239], v1, s[8:11], s60 offen offset:3072 sc1
  s_add_u32 s60, s60, 12288
  s_sleep 1
L_w2done_103:
  s_barrier
  s_sub_u32 s52, s46, 4
  s_lshl_b32 s52, s52, 13
  v_add_u32 v6, s52, v1
  v_add_u32 v7, 65536, v6
  s_waitcnt vmcnt(48)
  ds_write_b128 v6, v[16:19] offset:0
  ds_write_b128 v6, v[20:23] offset:1024
  ds_write_b128 v6, v[24:27] offset:2048
  ds_write_b128 v6, v[28:31] offset:3072
  ds_write_b128 v6, v[32:35] offset:4096
  ds_write_b128 v6, v[36:39] offset:5120
  ds_write_b128 v6, v[40:43] offset:6144
  ds_write_b128 v6, v[44:47] offset:7168
  s_waitcnt vmcnt(40)
  ds_write_b128 v6, v[48:51] offset:32768
  ds_write_b128 v6, v[52:55] offset:33792
  ds_write_b128 v6, v[56:59] offset:34816
  ds_write_b128 v6, v[60:63] offset:35840
  ds_write_b128 v6, v[64:67] offset:36864
  ds_write_b128 v6, v[68:71] offset:37888
  ds_write_b128 v6, v[72:75] offset:38912
  ds_write_b128 v6, v[76:79] offset:39936
  s_waitcnt vmcnt(32)
  ds_write_b128 v7, v[80:83] offset:0
  ds_write_b128 v7, v[84:87] offset:1024
  ds_write_b128 v7, v[88:91] offset:2048
  ds_write_b128 v7, v[92:95] offset:3072
  ds_write_b128 v7, v[96:99] offset:4096
  ds_write_b128 v7, v[100:103] offset:5120
  ds_write_b128 v7, v[104:107] offset:6144
  ds_write_b128 v7, v[108:111] offset:7168
  s_waitcnt vmcnt(24)
  ds_write_b128 v7, v[112:115] offset:32768
  ds_write_b128 v7, v[116:119] offset:33792
  ds_write_b128 v7, v[120:123] offset:34816
  ds_write_b128 v7, v[124:127] offset:35840
  ds_write_b128 v7, v[128:131] offset:36864
  ds_write_b128 v7, v[132:135] offset:37888
  ds_write_b128 v7, v[136:139] offset:38912
  ds_write_b128 v7, v[140:143] offset:39936
  s_waitcnt lgkmcnt(0)
  s_barrier
  s_cmp_eq_u32 s48, 1
  s_cbranch_scc1 L_nopfq_104
  s_lshr_b32 s52, s2, 3
  s_mul_i32 s52, s52, 49152
  s_sub_u32 s53, s46, 4
  s_mul_i32 s53, s53, 12288
  s_add_u32 s52, s52, s53
  s_add_u32 s52, s52, 25165824
  buffer_load_dwordx4 v[244:247], v1, s[8:11], s52 offen offset:0
  buffer_load_dwordx4 v[244:247], v1, s[8:11], s52 offen offset:1024
  buffer_load_dwordx4 v[244:247], v1, s[8:11], s52 offen offset:2048
  buffer_load_dwordx4 v[244:247], v1, s[8:11], s52 offen offset:3072
  s_add_u32 s52, s52, 4096
  buffer_load_dwordx4 v[244:247], v1, s[8:11], s52 offen offset:0
  buffer_load_dwordx4 v[244:247], v1, s[8:11], s52 offen offset:1024
  buffer_load_dwordx4 v[244:247], v1, s[8:11], s52 offen offset:2048
  buffer_load_dwordx4 v[244:247], v1, s[8:11], s52 offen offset:3072
  s_add_u32 s52, s52, 4096
  buffer_load_dwordx4 v[244:247], v1, s[8:11], s52 offen offset:0
  buffer_load_dwordx4 v[244:247], v1, s[8:11], s52 offen offset:1024
  buffer_load_dwordx4 v[244:247], v1, s[8:11], s52 offen offset:2048
  buffer_load_dwordx4 v[244:247], v1, s[8:11], s52 offen offset:3072
L_nopfq_104:
  s_barrier
  s_barrier
  s_cmp_eq_u32 s48, 1
  s_cbranch_scc1 L_wa_105
  s_waitcnt vmcnt(28)
  s_branch L_wb_106
L_wa_105:
  s_waitcnt vmcnt(16)
L_wb_106:
  ds_write_b128 v6, v[144:147] offset:0
  ds_write_b128 v6, v[148:151] offset:1024
  ds_write_b128 v6, v[152:155] offset:2048
  ds_write_b128 v6, v[156:159] offset:3072
  ds_write_b128 v6, v[160:163] offset:4096
  ds_write_b128 v6, v[164:167] offset:5120
  ds_write_b128 v6, v[168:171] offset:6144
  ds_write_b128 v6, v[172:175] offset:7168
  s_waitcnt lgkmcnt(0)
  s_barrier
  s_cmp_eq_u32 s48, 1
  s_cbranch_scc1 L_wa_107
  s_waitcnt vmcnt(20)
  s_branch L_wb_108
L_wa_107:
  s_waitcnt vmcnt(8)
L_wb_108:
  ds_write_b128 v6, v[176:179] offset:32768
  ds_write_b128 v6, v[180:183] offset:33792
  ds_write_b128 v6, v[184:187] offset:34816
  ds_write_b128 v6, v[188:191] offset:35840
  ds_write_b128 v6, v[192:195] offset:36864
  ds_write_b128 v6, v[196:199] offset:37888
  ds_write_b128 v6, v[200:203] offset:38912
  ds_write_b128 v6, v[204:207] offset:39936
  s_waitcnt lgkmcnt(0)
  s_barrier
  s_cmp_eq_u32 s48, 1
  s_cbranch_scc1 L_wa_109
  s_waitcnt vmcnt(12)
  s_branch L_wb_110
L_wa_109:
  s_waitcnt vmcnt(0)
L_wb_110:
  ds_write_b128 v7, v[208:211] offset:0
  ds_write_b128 v7, v[212:215] offset:1024
  ds_write_b128 v7, v[216:219] offset:2048
  ds_write_b128 v7, v[220:223] offset:3072
  ds_write_b128 v7, v[224:227] offset:4096
  ds_write_b128 v7, v[228:231] offset:5120
  ds_write_b128 v7, v[232:235] offset:6144
  ds_write_b128 v7, v[236:239] offset:7168
  s_waitcnt lgkmcnt(0)
  s_barrier
  s_barrier
  s_barrier
  s_cmp_eq_u32 s48, 1
  s_cbranch_scc1 L_end
  s_cmp_lt_u32 s46, 5
  s_cbranch_scc1 L_skip_111
  s_sub_u32 s52, s46, 5
  s_lshl_b32 s52, s52, 15
  s_mul_i32 s53, s45, 98304
  s_add_u32 s53, s53, s52
  s_add_u32 s53, s53, 25165824
  s_add_u32 m0, s52, 0
  s_mov_b32 s91, 16
L_dma_112:
  buffer_load_dwordx4 v1, s[8:11], s53 offen sc1 lds
  s_add_u32 m0, m0, 1024
  s_add_u32 s53, s53, 1024
  s_sub_u32 s91, s91, 1
  s_cmp_lg_u32 s91, 0
  s_cbranch_scc1 L_dma_112
L_skip_111:
  s_mov_b32 s48, 1
  s_mov_b32 s94, 2097152
  s_branch L_p1_helper_l1
L_p4_compute:
  s_cmp_ge_u32 s45, 14
  s_cbranch_scc1 L_p4idle_113
  s_lshl_b32 s90, s48, 2
  s_add_u32 s90, s90, 2
  v_lshlrev_b32 v4, 2, v0
  s_mov_b32 s91, 262144
  s_cmp_eq_u32 s51, 0
  s_cbranch_scc0 L_pdone_116
L_poll_115:
  buffer_load_dword v5, v4, s[8:11], s49 offen sc1
  s_waitcnt vmcnt(0)
  v_cmp_gt_u32 vcc, s90, v5
  s_cbranch_vccz L_pdone_116
  s_sleep 1
  s_sub_u32 s91, s91, 1
  s_cbranch_scc0 L_poll_115
  s_mov_b32 s51, 1
L_pdone_116:
  s_lshl_b32 s56, s44, 2
  s_add_u32 s56, s56, s46
  s_mul_i32 s61, s56, 32768
  s_add_u32 s61, s61, 3145728
  buffer_load_dwordx4 v[80:83], v1, s[8:11], s61 offen offset:0 sc1
  buffer_load_dwordx4 v[84:87], v1, s[8:11], s61 offen offset:1024 sc1
  buffer_load_dwordx4 v[88:91], v1, s[8:11], s61 offen offset:2048 sc1
  buffer_load_dwordx4 v[92:95], v1, s[8:11], s61 offen offset:3072 sc1
  s_add_u32 s61, s61, 4096
  buffer_load_dwordx4 v[96:99], v1, s[8:11], s61 offen offset:0 sc1
  buffer_load_dwordx4 v[100:103], v1, s[8:11], s61 offen offset:1024 sc1
  buffer_load_dwordx4 v[104:107], v1, s[8:11], s61 offen offset:2048 sc1
  buffer_load_dwordx4 v[108:111], v1, s[8:11], s61 offen offset:3072 sc1
  v_lshrrev_b32 v4, 5, v0
  v_lshlrev_b32 v4, 11, v4
  v_and_b32 v5, 31, v0
  v_lshl_add_u32 v4, v5, 3, v4
  s_lshl_b32 s57, s56, 12
  s_add_u32 s57, s57, 7602176
  buffer_load_dwordx2 v[232:233], v4, s[8:11], s57 offen offset:0 sc1
  buffer_load_dwordx2 v[234:235], v4, s[8:11], s57 offen offset:256 sc1
  buffer_load_dwordx2 v[236:237], v4, s[8:11], s57 offen offset:512 sc1
  buffer_load_dwordx2 v[238:239], v4, s[8:11], s57 offen offset:768 sc1
  buffer_load_dwordx2 v[240:241], v4, s[8:11], s57 offen offset:1024 sc1
  buffer_load_dwordx2 v[242:243], v4, s[8:11], s57 offen offset:1280 sc1
  buffer_load_dwordx2 v[244:245], v4, s[8:11], s57 offen offset:1536 sc1
  buffer_load_dwordx2 v[246:247], v4, s[8:11], s57 offen offset:1792 sc1
  v_lshrrev_b32 v4, 5, v0
  v_lshlrev_b32 v4, 2, v4
  v_bfe_u32 v6, v0, 2, 2
  v_add_u32 v4, v4, v6
  v_bfe_u32 v5, v0, 4, 1
  v_lshlrev_b32 v5, 5, v5
  v_and_b32 v6, 3, v0
  v_lshlrev_b32 v6, 3, v6
  v_add_u32 v5, v5, v6
  v_lshl_add_u32 v5, v4, 8, v5
  v_and_b32 v8, 3, v4
  v_xor_b32 v9, 0, v8
  v_lshl_add_u32 v10, v9, 6, v5
  v_xor_b32 v9, 1, v8
  v_lshl_add_u32 v11, v9, 6, v5
  v_xor_b32 v9, 2, v8
  v_lshl_add_u32 v12, v9, 6, v5
  v_xor_b32 v9, 3, v8
  v_lshl_add_u32 v13, v9, 6, v5
  v_lshrrev_b32 v8, 5, v0
  v_lshlrev_b32 v8, 4, v8
  v_add_u32 v8, 162304, v8
  s_mul_i32 s52, s56, 114688
  s_lshl_b32 s53, s45, 13
  s_add_u32 s52, s52, s53
  s_add_u32 s52, s52, 16777216
  s_barrier
  ds_read_b64_tr_b16 v[208:209], v10 offset:0
  ds_read_b64_tr_b16 v[210:211], v10 offset:2048
  ds_read_b64_tr_b16 v[212:213], v11 offset:0
  ds_read_b64_tr_b16 v[214:215], v11 offset:2048
  ds_read_b64_tr_b16 v[216:217], v12 offset:0
  ds_read_b64_tr_b16 v[218:219], v12 offset:2048
  ds_read_b64_tr_b16 v[220:221], v10 offset:4096
  ds_read_b64_tr_b16 v[222:223], v10 offset:6144
  ds_read_b64_tr_b16 v[224:225], v11 offset:4096
  ds_read_b64_tr_b16 v[226:227], v11 offset:6144
  s_waitcnt vmcnt(15)
  s_add_u32 s61, s61, 4096
  buffer_load_dwordx4 v[112:115], v1, s[8:11], s61 offen offset:0 sc1
  s_waitcnt lgkmcnt(8)
  v_mfma_f32_32x32x16_bf16 v[16:31], v[208:211], v[80:83], 0
  ds_read_b64_tr_b16 v[228:229], v12 offset:4096
  ds_read_b64_tr_b16 v[230:231], v12 offset:6144
  s_waitcnt lgkmcnt(8)
  v_mfma_f32_32x32x16_bf16 v[32:47], v[212:215], v[80:83], 0
  ds_read_b64_tr_b16 v[208:209], v10 offset:8192
  ds_read_b64_tr_b16 v[210:211], v10 offset:10240
  s_waitcnt lgkmcnt(8)
  v_mfma_f32_32x32x16_bf16 v[48:63], v[216:219], v[80:83], 0
  ds_read_b64_tr_b16 v[212:213], v11 offset:8192
  ds_read_b64_tr_b16 v[214:215], v11 offset:10240
  s_waitcnt vmcnt(15)
  buffer_load_dwordx4 v[116:119], v1, s[8:11], s61 offen offset:1024 sc1
  s_waitcnt lgkmcnt(8)
  v_mfma_f32_32x32x16_bf16 v[16:31], v[220:223], v[84:87], v[16:31]
  ds_read_b64_tr_b16 v[216:217], v12 offset:8192
  ds_read_b64_tr_b16 v[218:219], v12 offset:10240
  s_waitcnt lgkmcnt(8)
  v_mfma_f32_32x32x16_bf16 v[32:47], v[224:227], v[84:87], v[32:47]
  ds_read_b64_tr_b16 v[220:221], v10 offset:12288
  ds_read_b64_tr_b16 v[222:223], v10 offset:14336
  s_waitcnt lgkmcnt(8)
  v_mfma_f32_32x32x16_bf16 v[48:63], v[228:231], v[84:87], v[48:63]
  ds_read_b64_tr_b16 v[224:225], v11 offset:12288
  ds_read_b64_tr_b16 v[226:227], v11 offset:14336
  s_waitcnt vmcnt(15)
  buffer_load_dwordx4 v[120:123], v1, s[8:11], s61 offen offset:2048 sc1
  s_waitcnt lgkmcnt(8)
  v_mfma_f32_32x32x16_bf16 v[16:31], v[208:211], v[88:91], v[16:31]
  ds_read_b64_tr_b16 v[228:229], v12 offset:12288
  ds_read_b64_tr_b16 v[230:231], v12 offset:14336
  s_waitcnt lgkmcnt(8)
  v_mfma_f32_32x32x16_bf16 v[32:47], v[212:215], v[88:91], v[32:47]
  ds_read_b64_tr_b16 v[208:209], v10 offset:16384
  ds_read_b64_tr_b16 v[210:211], v10 offset:18432
  s_waitcnt lgkmcnt(8)
  v_mfma_f32_32x32x16_bf16 v[48:63], v[216:219], v[88:91], v[48:63]
  ds_read_b64_tr_b16 v[212:213], v11 offset:16384
  ds_read_b64_tr_b16 v[214:215], v11 offset:18432
  s_waitcnt vmcnt(15)
  buffer_load_dwordx4 v[124:127], v1, s[8:11], s61 offen offset:3072 sc1
  s_waitcnt lgkmcnt(8)
  v_mfma_f32_32x32x16_bf16 v[16:31], v[220:223], v[92:95], v[16:31]
  ds_read_b64_tr_b16 v[216:217], v12 offset:16384
  ds_read_b64_tr_b16 v[218:219], v12 offset:18432
  s_waitcnt lgkmcnt(8)
  v_mfma_f32_32x32x16_bf16 v[32:47], v[224:227], v[92:95], v[32:47]
  ds_read_b64_tr_b16 v[220:221], v10 offset:20480
  ds_read_b64_tr_b16 v[222:223], v10 offset:22528
  s_waitcnt lgkmcnt(8)
  v_mfma_f32_32x32x16_bf16 v[48:63], v[228:231], v[92:95], v[48:63]
  ds_read_b64_tr_b16 v[224:225], v11 offset:20480
  ds_read_b64_tr_b16 v[226:227], v11 offset:22528
  s_waitcnt vmcnt(15)
  s_add_u32 s61, s61, 4096
  buffer_load_dwordx4 v[128:131], v1, s[8:11], s61 offen offset:0 sc1
  s_waitcnt lgkmcnt(8)
  v_mfma_f32_32x32x16_bf16 v[16:31], v[208:211], v[96:99], v[16:31]
  ds_read_b64_tr_b16 v[228:229], v12 offset:20480
  ds_read_b64_tr_b16 v[230:231], v12 offset:22528
  s_waitcnt lgkmcnt(8)
  v_mfma_f32_32x32x16_bf16 v[32:47], v[212:215], v[96:99], v[32:47]
  ds_read_b64_tr_b16 v[208:209], v10 offset:24576
  ds_read_b64_tr_b16 v[210:211], v10 offset:26624
  s_waitcnt lgkmcnt(8)
  v_mfma_f32_32x32x16_bf16 v[48:63], v[216:219], v[96:99], v[48:63]
  ds_read_b64_tr_b16 v[212:213], v11 offset:24576
  ds_read_b64_tr_b16 v[214:215], v11 offset:26624
  s_waitcnt vmcnt(15)
  buffer_load_dwordx4 v[132:135], v1, s[8:11], s61 offen offset:1024 sc1
  s_waitcnt lgkmcnt(8)
  v_mfma_f32_32x32x16_bf16 v[16:31], v[220:223], v[100:103], v[16:31]
  ds_read_b64_tr_b16 v[216:217], v12 offset:24576
  ds_read_b64_tr_b16 v[218:219], v12 offset:26624
  s_waitcnt lgkmcnt(8)
  v_mfma_f32_32x32x16_bf16 v[32:47], v[224:227], v[100:103], v[32:47]
  ds_read_b64_tr_b16 v[220:221], v10 offset:28672
  ds_read_b64_tr_b16 v[222:223], v10 offset:30720
  s_waitcnt lgkmcnt(8)
  v_mfma_f32_32x32x16_bf16 v[48:63], v[228:231], v[100:103], v[48:63]
  ds_read_b64_tr_b16 v[224:225], v11 offset:28672
  ds_read_b64_tr_b16 v[226:227], v11 offset:30720
  s_waitcnt vmcnt(15)
  buffer_load_dwordx4 v[136:139], v1, s[8:11], s61 offen offset:2048 sc1
  s_waitcnt lgkmcnt(8)
  v_mfma_f32_32x32x16_bf16 v[16:31], v[208:211], v[104:107], v[16:31]
  ds_read_b64_tr_b16 v[228:229], v12 offset:28672
  ds_read_b64_tr_b16 v[230:231], v12 offset:30720
  s_waitcnt lgkmcnt(8)
  v_mfma_f32_32x32x16_bf16 v[32:47], v[212:215], v[104:107], v[32:47]
  ds_read_b64_tr_b16 v[208:209], v10 offset:32768
  ds_read_b64_tr_b16 v[210:211], v10 offset:34816
  s_waitcnt lgkmcnt(8)
  v_mfma_f32_32x32x16_bf16 v[48:63], v[216:219], v[104:107], v[48:63]
  ds_read_b64_tr_b16 v[212:213], v11 offset:32768
  ds_read_b64_tr_b16 v[214:215], v11 offset:34816
  s_waitcnt vmcnt(15)
  buffer_load_dwordx4 v[140:143], v1, s[8:11], s61 offen offset:3072 sc1
  s_waitcnt lgkmcnt(8)
  v_mfma_f32_32x32x16_bf16 v[16:31], v[220:223], v[108:111], v[16:31]
  ds_read_b64_tr_b16 v[216:217], v12 offset:32768
  ds_read_b64_tr_b16 v[218:219], v12 offset:34816
  s_waitcnt lgkmcnt(8)
  v_mfma_f32_32x32x16_bf16 v[32:47], v[224:227], v[108:111], v[32:47]
  ds_read_b64_tr_b16 v[220:221], v10 offset:36864
  ds_read_b64_tr_b16 v[222:223], v10 offset:38912
  s_waitcnt lgkmcnt(8)
  v_mfma_f32_32x32x16_bf16 v[48:63], v[228:231], v[108:111], v[48:63]
  ds_read_b64_tr_b16 v[224:225], v11 offset:36864
  ds_read_b64_tr_b16 v[226:227], v11 offset:38912
  s_waitcnt vmcnt(7)
  s_add_u32 s61, s61, 4096
  buffer_load_dwordx4 v[144:147], v1, s[8:11], s61 offen offset:0 sc1
  s_waitcnt lgkmcnt(8)
  v_mfma_f32_32x32x16_bf16 v[16:31], v[208:211], v[112:115], v[16:31]
  ds_read_b64_tr_b16 v[228:229], v12 offset:36864
  ds_read_b64_tr_b16 v[230:231], v12 offset:38912
  v_pk_add_f32 v[232:233], v[232:233], v[234:235]
  v_pk_add_f32 v[236:237], v[236:237], v[238:239]
  v_pk_add_f32 v[240:241], v[240:241], v[242:243]
  v_pk_add_f32 v[244:245], v[244:245], v[246:247]
  v_pk_add_f32 v[232:233], v[232:233], v[236:237]
  v_pk_add_f32 v[240:241], v[240:241], v[244:245]
  v_pk_add_f32 v[232:233], v[232:233], v[240:241]
  v_mov_b32 v234, v232
  v_mov_b32 v235, v233
  s_nop 1
  v_permlane32_swap_b32 v234, v232
  v_permlane32_swap_b32 v235, v233
  s_nop 0
  v_pk_add_f32 v[232:233], v[232:233], v[234:235]
  v_mul_f32 v232, 0x3b000000, v232
  v_mul_f32 v233, 0x3b000000, v233
  v_fma_f32 v233, -v232, v232, v233
  v_max_f32 v233, 0, v233
  v_add_f32 v233, 0x3727c5ac, v233
  v_rsq_f32 v4, v233
  s_nop 0
  v_mul_f32 v6, v232, v4
  s_waitcnt lgkmcnt(8)
  v_mfma_f32_32x32x16_bf16 v[32:47], v[212:215], v[112:115], v[32:47]
  ds_read_b64_tr_b16 v[208:209], v10 offset:40960
  ds_read_b64_tr_b16 v[210:211], v10 offset:43008
  s_waitcnt lgkmcnt(8)
  v_mfma_f32_32x32x16_bf16 v[48:63], v[216:219], v[112:115], v[48:63]
  ds_read_b64_tr_b16 v[212:213], v11 offset:40960
  ds_read_b64_tr_b16 v[214:215], v11 offset:43008
  s_waitcnt vmcnt(7)
  buffer_load_dwordx4 v[148:151], v1, s[8:11], s61 offen offset:1024 sc1
  s_waitcnt lgkmcnt(8)
  v_mfma_f32_32x32x16_bf16 v[16:31], v[220:223], v[116:119], v[16:31]
  ds_read_b64_tr_b16 v[216:217], v12 offset:40960
  ds_read_b64_tr_b16 v[218:219], v12 offset:43008
  s_waitcnt lgkmcnt(8)
  v_mfma_f32_32x32x16_bf16 v[32:47], v[224:227], v[116:119], v[32:47]
  ds_read_b64_tr_b16 v[220:221], v10 offset:45056
  ds_read_b64_tr_b16 v[222:223], v10 offset:47104
  s_waitcnt lgkmcnt(8)
  v_mfma_f32_32x32x16_bf16 v[48:63], v[228:231], v[116:119], v[48:63]
  ds_read_b64_tr_b16 v[224:225], v11 offset:45056
  ds_read_b64_tr_b16 v[226:227], v11 offset:47104
  s_waitcnt vmcnt(7)
  buffer_load_dwordx4 v[152:155], v1, s[8:11], s61 offen offset:2048 sc1
  s_waitcnt lgkmcnt(8)
  v_mfma_f32_32x32x16_bf16 v[16:31], v[208:211], v[120:123], v[16:31]
  ds_read_b64_tr_b16 v[228:229], v12 offset:45056
  ds_read_b64_tr_b16 v[230:231], v12 offset:47104
  s_waitcnt lgkmcnt(8)
  v_mfma_f32_32x32x16_bf16 v[32:47], v[212:215], v[120:123], v[32:47]
  ds_read_b64_tr_b16 v[208:209], v10 offset:49152
  ds_read_b64_tr_b16 v[210:211], v10 offset:51200
  s_waitcnt lgkmcnt(8)
  v_mfma_f32_32x32x16_bf16 v[48:63], v[216:219], v[120:123], v[48:63]
  ds_read_b64_tr_b16 v[212:213], v11 offset:49152
  ds_read_b64_tr_b16 v[214:215], v11 offset:51200
  s_waitcnt vmcnt(7)
  buffer_load_dwordx4 v[156:159], v1, s[8:11], s61 offen offset:3072 sc1
  s_waitcnt lgkmcnt(8)
  v_mfma_f32_32x32x16_bf16 v[16:31], v[220:223], v[124:127], v[16:31]
  ds_read_b64_tr_b16 v[216:217], v12 offset:49152
  ds_read_b64_tr_b16 v[218:219], v12 offset:51200
  s_waitcnt lgkmcnt(8)
  v_mfma_f32_32x32x16_bf16 v[32:47], v[224:227], v[124:127], v[32:47]
  ds_read_b64_tr_b16 v[220:221], v10 offset:53248
  ds_read_b64_tr_b16 v[222:223], v10 offset:55296
  s_waitcnt lgkmcnt(8)
  v_mfma_f32_32x32x16_bf16 v[48:63], v[228:231], v[124:127], v[48:63]
  ds_read_b64_tr_b16 v[224:225], v11 offset:53248
  ds_read_b64_tr_b16 v[226:227], v11 offset:55296
  s_waitcnt vmcnt(7)
  s_add_u32 s61, s61, 4096
  buffer_load_dwordx4 v[160:163], v1, s[8:11], s61 offen offset:0 sc1
  s_waitcnt lgkmcnt(8)
  v_mfma_f32_32x32x16_bf16 v[16:31], v[208:211], v[128:131], v[16:31]
  ds_read_b64_tr_b16 v[228:229], v12 offset:53248
  ds_read_b64_tr_b16 v[230:231], v12 offset:55296
  s_waitcnt lgkmcnt(8)
  v_mfma_f32_32x32x16_bf16 v[32:47], v[212:215], v[128:131], v[32:47]
  ds_read_b64_tr_b16 v[208:209], v10 offset:57344
  ds_read_b64_tr_b16 v[210:211], v10 offset:59392
  s_waitcnt lgkmcnt(8)
  v_mfma_f32_32x32x16_bf16 v[48:63], v[216:219], v[128:131], v[48:63]
  ds_read_b64_tr_b16 v[212:213], v11 offset:57344
  ds_read_b64_tr_b16 v[214:215], v11 offset:59392
  s_waitcnt vmcnt(7)
  buffer_load_dwordx4 v[164:167], v1, s[8:11], s61 offen offset:1024 sc1
  s_waitcnt lgkmcnt(8)
  v_mfma_f32_32x32x16_bf16 v[16:31], v[220:223], v[132:135], v[16:31]
  ds_read_b64_tr_b16 v[216:217], v12 offset:57344
  ds_read_b64_tr_b16 v[218:219], v12 offset:59392
  s_waitcnt lgkmcnt(8)
  v_mfma_f32_32x32x16_bf16 v[32:47], v[224:227], v[132:135], v[32:47]
  ds_read_b64_tr_b16 v[220:221], v10 offset:61440
  ds_read_b64_tr_b16 v[222:223], v10 offset:63488
  s_waitcnt lgkmcnt(8)
  v_mfma_f32_32x32x16_bf16 v[48:63], v[228:231], v[132:135], v[48:63]
  ds_read_b64_tr_b16 v[224:225], v11 offset:61440
  ds_read_b64_tr_b16 v[226:227], v11 offset:63488
  s_waitcnt vmcnt(7)
  buffer_load_dwordx4 v[168:171], v1, s[8:11], s61 offen offset:2048 sc1
  s_waitcnt lgkmcnt(8)
  v_mfma_f32_32x32x16_bf16 v[16:31], v[208:211], v[136:139], v[16:31]
  ds_read_b64_tr_b16 v[228:229], v12 offset:61440
  ds_read_b64_tr_b16 v[230:231], v12 offset:63488
  s_waitcnt lgkmcnt(8)
  v_mfma_f32_32x32x16_bf16 v[32:47], v[212:215], v[136:139], v[32:47]
  v_add_u32 v10, 65536, v10
  ds_read_b64_tr_b16 v[208:209], v10 offset:0
  ds_read_b64_tr_b16 v[210:211], v10 offset:2048
  s_waitcnt lgkmcnt(8)
  v_mfma_f32_32x32x16_bf16 v[48:63], v[216:219], v[136:139], v[48:63]
  v_add_u32 v11, 65536, v11
  ds_read_b64_tr_b16 v[212:213], v11 offset:0
  ds_read_b64_tr_b16 v[214:215], v11 offset:2048
  s_waitcnt vmcnt(7)
  buffer_load_dwordx4 v[172:175], v1, s[8:11], s61 offen offset:3072 sc1
  s_waitcnt lgkmcnt(8)
  v_mfma_f32_32x32x16_bf16 v[16:31], v[220:223], v[140:143], v[16:31]
  v_add_u32 v12, 65536, v12
  ds_read_b64_tr_b16 v[216:217], v12 offset:0
  ds_read_b64_tr_b16 v[218:219], v12 offset:2048
  s_waitcnt lgkmcnt(8)
  v_mfma_f32_32x32x16_bf16 v[32:47], v[224:227], v[140:143], v[32:47]
  ds_read_b64_tr_b16 v[220:221], v10 offset:4096
  ds_read_b64_tr_b16 v[222:223], v10 offset:6144
  s_waitcnt lgkmcnt(8)
  v_mfma_f32_32x32x16_bf16 v[48:63], v[228:231], v[140:143], v[48:63]
  ds_read_b64_tr_b16 v[224:225], v11 offset:4096
  ds_read_b64_tr_b16 v[226:227], v11 offset:6144
  s_waitcnt vmcnt(7)
  s_add_u32 s61, s61, 4096
  buffer_load_dwordx4 v[176:179], v1, s[8:11], s61 offen offset:0 sc1
  s_waitcnt lgkmcnt(8)
  v_mfma_f32_32x32x16_bf16 v[16:31], v[208:211], v[144:147], v[16:31]
  ds_read_b64_tr_b16 v[228:229], v12 offset:4096
  ds_read_b64_tr_b16 v[230:231], v12 offset:6144
  s_waitcnt lgkmcnt(8)
  v_mfma_f32_32x32x16_bf16 v[32:47], v[212:215], v[144:147], v[32:47]
  ds_read_b64_tr_b16 v[208:209], v10 offset:8192
  ds_read_b64_tr_b16 v[210:211], v10 offset:10240
  s_waitcnt lgkmcnt(8)
  v_mfma_f32_32x32x16_bf16 v[48:63], v[216:219], v[144:147], v[48:63]
  ds_read_b64_tr_b16 v[212:213], v11 offset:8192
  ds_read_b64_tr_b16 v[214:215], v11 offset:10240
  s_waitcnt vmcnt(7)
  buffer_load_dwordx4 v[180:183], v1, s[8:11], s61 offen offset:1024 sc1
  s_waitcnt lgkmcnt(8)
  v_mfma_f32_32x32x16_bf16 v[16:31], v[220:223], v[148:151], v[16:31]
  ds_read_b64_tr_b16 v[216:217], v12 offset:8192
  ds_read_b64_tr_b16 v[218:219], v12 offset:10240
  s_waitcnt lgkmcnt(8)
  v_mfma_f32_32x32x16_bf16 v[32:47], v[224:227], v[148:151], v[32:47]
  ds_read_b64_tr_b16 v[220:221], v10 offset:12288
  ds_read_b64_tr_b16 v[222:223], v10 offset:14336
  s_waitcnt lgkmcnt(8)
  v_mfma_f32_32x32x16_bf16 v[48:63], v[228:231], v[148:151], v[48:63]
  ds_read_b64_tr_b16 v[224:225], v11 offset:12288
  ds_read_b64_tr_b16 v[226:227], v11 offset:14336
  s_waitcnt vmcnt(7)
  buffer_load_dwordx4 v[184:187], v1, s[8:11], s61 offen offset:2048 sc1
  s_waitcnt lgkmcnt(8)
  v_mfma_f32_32x32x16_bf16 v[16:31], v[208:211], v[152:155], v[16:31]
  ds_read_b64_tr_b16 v[228:229], v12 offset:12288
  ds_read_b64_tr_b16 v[230:231], v12 offset:14336
  s_waitcnt lgkmcnt(8)
  v_mfma_f32_32x32x16_bf16 v[32:47], v[212:215], v[152:155], v[32:47]
  ds_read_b64_tr_b16 v[208:209], v10 offset:16384
  ds_read_b64_tr_b16 v[210:211], v10 offset:18432
  s_waitcnt lgkmcnt(8)
  v_mfma_f32_32x32x16_bf16 v[48:63], v[216:219], v[152:155], v[48:63]
  ds_read_b64_tr_b16 v[212:213], v11 offset:16384
  ds_read_b64_tr_b16 v[214:215], v11 offset:18432
  s_waitcnt vmcnt(7)
  buffer_load_dwordx4 v[188:191], v1, s[8:11], s61 offen offset:3072 sc1
  s_waitcnt lgkmcnt(8)
  v_mfma_f32_32x32x16_bf16 v[16:31], v[220:223], v[156:159], v[16:31]
  ds_read_b64_tr_b16 v[216:217], v12 offset:16384
  ds_read_b64_tr_b16 v[218:219], v12 offset:18432
  s_waitcnt lgkmcnt(8)
  v_mfma_f32_32x32x16_bf16 v[32:47], v[224:227], v[156:159], v[32:47]
  ds_read_b64_tr_b16 v[220:221], v10 offset:20480
  ds_read_b64_tr_b16 v[222:223], v10 offset:22528
  s_waitcnt lgkmcnt(8)
  v_mfma_f32_32x32x16_bf16 v[48:63], v[228:231], v[156:159], v[48:63]
  ds_read_b64_tr_b16 v[224:225], v11 offset:20480
  ds_read_b64_tr_b16 v[226:227], v11 offset:22528
  s_waitcnt vmcnt(7)
  s_add_u32 s61, s61, 4096
  buffer_load_dwordx4 v[192:195], v1, s[8:11], s61 offen offset:0 sc1
  s_waitcnt lgkmcnt(8)
  v_mfma_f32_32x32x16_bf16 v[16:31], v[208:211], v[160:163], v[16:31]
  ds_read_b64_tr_b16 v[228:229], v12 offset:20480
  ds_read_b64_tr_b16 v[230:231], v12 offset:22528
  s_waitcnt lgkmcnt(8)
  v_mfma_f32_32x32x16_bf16 v[32:47], v[212:215], v[160:163], v[32:47]
  ds_read_b64_tr_b16 v[208:209], v10 offset:24576
  ds_read_b64_tr_b16 v[210:211], v10 offset:26624
  s_waitcnt lgkmcnt(8)
  v_mfma_f32_32x32x16_bf16 v[48:63], v[216:219], v[160:163], v[48:63]
  ds_read_b64_tr_b16 v[212:213], v11 offset:24576
  ds_read_b64_tr_b16 v[214:215], v11 offset:26624
  s_waitcnt vmcnt(7)
  buffer_load_dwordx4 v[196:199], v1, s[8:11], s61 offen offset:1024 sc1
  s_waitcnt lgkmcnt(8)
  v_mfma_f32_32x32x16_bf16 v[16:31], v[220:223], v[164:167], v[16:31]
  ds_read_b64_tr_b16 v[216:217], v12 offset:24576
  ds_read_b64_tr_b16 v[218:219], v12 offset:26624
  s_waitcnt lgkmcnt(8)
  v_mfma_f32_32x32x16_bf16 v[32:47], v[224:227], v[164:167], v[32:47]
  ds_read_b64_tr_b16 v[220:221], v10 offset:28672
  ds_read_b64_tr_b16 v[222:223], v10 offset:30720
  s_waitcnt lgkmcnt(8)
  v_mfma_f32_32x32x16_bf16 v[48:63], v[228:231], v[164:167], v[48:63]
  ds_read_b64_tr_b16 v[224:225], v11 offset:28672
  ds_read_b64_tr_b16 v[226:227], v11 offset:30720
  s_waitcnt vmcnt(7)
  buffer_load_dwordx4 v[200:203], v1, s[8:11], s61 offen offset:2048 sc1
  s_waitcnt lgkmcnt(8)
  v_mfma_f32_32x32x16_bf16 v[16:31], v[208:211], v[168:171], v[16:31]
  ds_read_b64_tr_b16 v[228:229], v12 offset:28672
  ds_read_b64_tr_b16 v[230:231], v12 offset:30720
  s_waitcnt lgkmcnt(8)
  v_mfma_f32_32x32x16_bf16 v[32:47], v[212:215], v[168:171], v[32:47]
  ds_read_b64_tr_b16 v[208:209], v10 offset:32768
  ds_read_b64_tr_b16 v[210:211], v10 offset:34816
  s_waitcnt lgkmcnt(8)
  v_mfma_f32_32x32x16_bf16 v[48:63], v[216:219], v[168:171], v[48:63]
  ds_read_b64_tr_b16 v[212:213], v11 offset:32768
  ds_read_b64_tr_b16 v[214:215], v11 offset:34816
  s_waitcnt vmcnt(7)
  buffer_load_dwordx4 v[204:207], v1, s[8:11], s61 offen offset:3072 sc1
  s_waitcnt lgkmcnt(8)
  v_mfma_f32_32x32x16_bf16 v[16:31], v[220:223], v[172:175], v[16:31]
  ds_read_b64_tr_b16 v[216:217], v12 offset:32768
  ds_read_b64_tr_b16 v[218:219], v12 offset:34816
  s_waitcnt lgkmcnt(8)
  v_mfma_f32_32x32x16_bf16 v[32:47], v[224:227], v[172:175], v[32:47]
  ds_read_b64_tr_b16 v[220:221], v10 offset:36864
  ds_read_b64_tr_b16 v[222:223], v10 offset:38912
  s_waitcnt lgkmcnt(8)
  v_mfma_f32_32x32x16_bf16 v[48:63], v[228:231], v[172:175], v[48:63]
  ds_read_b64_tr_b16 v[224:225], v11 offset:36864
  ds_read_b64_tr_b16 v[226:227], v11 offset:38912
  s_waitcnt vmcnt(7)
  s_waitcnt lgkmcnt(8)
  v_mfma_f32_32x32x16_bf16 v[16:31], v[208:211], v[176:179], v[16:31]
  ds_read_b64_tr_b16 v[228:229], v12 offset:36864
  ds_read_b64_tr_b16 v[230:231], v12 offset:38912
  s_waitcnt lgkmcnt(8)
  v_mfma_f32_32x32x16_bf16 v[32:47], v[212:215], v[176:179], v[32:47]
  ds_read_b64_tr_b16 v[208:209], v10 offset:40960
  ds_read_b64_tr_b16 v[210:211], v10 offset:43008
  s_waitcnt lgkmcnt(8)
  v_mfma_f32_32x32x16_bf16 v[48:63], v[216:219], v[176:179], v[48:63]
  ds_read_b64_tr_b16 v[212:213], v11 offset:40960
  ds_read_b64_tr_b16 v[214:215], v11 offset:43008
  s_waitcnt vmcnt(6)
  s_waitcnt lgkmcnt(8)
  v_mfma_f32_32x32x16_bf16 v[16:31], v[220:223], v[180:183], v[16:31]
  ds_read_b64_tr_b16 v[216:217], v12 offset:40960
  ds_read_b64_tr_b16 v[218:219], v12 offset:43008
  s_waitcnt lgkmcnt(8)
  v_mfma_f32_32x32x16_bf16 v[32:47], v[224:227], v[180:183], v[32:47]
  ds_read_b64_tr_b16 v[220:221], v10 offset:45056
  ds_read_b64_tr_b16 v[222:223], v10 offset:47104
  s_waitcnt lgkmcnt(8)
  v_mfma_f32_32x32x16_bf16 v[48:63], v[228:231], v[180:183], v[48:63]
  ds_read_b64_tr_b16 v[224:225], v11 offset:45056
  ds_read_b64_tr_b16 v[226:227], v11 offset:47104
  s_waitcnt vmcnt(5)
  s_waitcnt lgkmcnt(8)
  v_mfma_f32_32x32x16_bf16 v[16:31], v[208:211], v[184:187], v[16:31]
  ds_read_b64_tr_b16 v[228:229], v12 offset:45056
  ds_read_b64_tr_b16 v[230:231], v12 offset:47104
  s_waitcnt lgkmcnt(8)
  v_mfma_f32_32x32x16_bf16 v[32:47], v[212:215], v[184:187], v[32:47]
  ds_read_b64_tr_b16 v[208:209], v10 offset:49152
  ds_read_b64_tr_b16 v[210:211], v10 offset:51200
  s_waitcnt lgkmcnt(8)
  v_mfma_f32_32x32x16_bf16 v[48:63], v[216:219], v[184:187], v[48:63]
  ds_read_b64_tr_b16 v[212:213], v11 offset:49152
  ds_read_b64_tr_b16 v[214:215], v11 offset:51200
  s_waitcnt vmcnt(4)
  s_waitcnt lgkmcnt(8)
  v_mfma_f32_32x32x16_bf16 v[16:31], v[220:223], v[188:191], v[16:31]
  ds_read_b64_tr_b16 v[216:217], v12 offset:49152
  ds_read_b64_tr_b16 v[218:219], v12 offset:51200
  s_waitcnt lgkmcnt(8)
  v_mfma_f32_32x32x16_bf16 v[32:47], v[224:227], v[188:191], v[32:47]
  ds_read_b64_tr_b16 v[220:221], v10 offset:53248
  ds_read_b64_tr_b16 v[222:223], v10 offset:55296
  s_waitcnt lgkmcnt(8)
  v_mfma_f32_32x32x16_bf16 v[48:63], v[228:231], v[188:191], v[48:63]
  ds_read_b64_tr_b16 v[224:225], v11 offset:53248
  ds_read_b64_tr_b16 v[226:227], v11 offset:55296
  s_waitcnt vmcnt(3)
  s_waitcnt lgkmcnt(8)
  v_mfma_f32_32x32x16_bf16 v[16:31], v[208:211], v[192:195], v[16:31]
  ds_read_b64_tr_b16 v[228:229], v12 offset:53248
  ds_read_b64_tr_b16 v[230:231], v12 offset:55296
  s_waitcnt lgkmcnt(8)
  v_mfma_f32_32x32x16_bf16 v[32:47], v[212:215], v[192:195], v[32:47]
  ds_read_b64_tr_b16 v[208:209], v10 offset:57344
  ds_read_b64_tr_b16 v[210:211], v10 offset:59392
  s_waitcnt lgkmcnt(8)
  v_mfma_f32_32x32x16_bf16 v[48:63], v[216:219], v[192:195], v[48:63]
  ds_read_b64_tr_b16 v[212:213], v11 offset:57344
  ds_read_b64_tr_b16 v[214:215], v11 offset:59392
  s_waitcnt vmcnt(2)
  s_waitcnt lgkmcnt(8)
  v_mfma_f32_32x32x16_bf16 v[16:31], v[220:223], v[196:199], v[16:31]
  ds_read_b64_tr_b16 v[216:217], v12 offset:57344
  ds_read_b64_tr_b16 v[218:219], v12 offset:59392
  s_waitcnt lgkmcnt(8)
  v_mfma_f32_32x32x16_bf16 v[32:47], v[224:227], v[196:199], v[32:47]
  ds_read_b64_tr_b16 v[220:221], v10 offset:61440
  ds_read_b64_tr_b16 v[222:223], v10 offset:63488
  s_waitcnt lgkmcnt(8)
  v_mfma_f32_32x32x16_bf16 v[48:63], v[228:231], v[196:199], v[48:63]
  ds_read_b64_tr_b16 v[224:225], v11 offset:61440
  ds_read_b64_tr_b16 v[226:227], v11 offset:63488
  s_waitcnt vmcnt(1)
  s_waitcnt lgkmcnt(8)
  v_mfma_f32_32x32x16_bf16 v[16:31], v[208:211], v[200:203], v[16:31]
  ds_read_b64_tr_b16 v[228:229], v12 offset:61440
  ds_read_b64_tr_b16 v[230:231], v12 offset:63488
  s_waitcnt lgkmcnt(8)
  v_mfma_f32_32x32x16_bf16 v[32:47], v[212:215], v[200:203], v[32:47]
  ds_read_b64_tr_b16 v[208:209], v13 offset:0
  ds_read_b64_tr_b16 v[210:211], v13 offset:2048
  s_waitcnt lgkmcnt(8)
  v_mfma_f32_32x32x16_bf16 v[48:63], v[216:219], v[200:203], v[48:63]
  ds_read_b64_tr_b16 v[212:213], v13 offset:4096
  ds_read_b64_tr_b16 v[214:215], v13 offset:6144
  s_waitcnt vmcnt(0)
  s_waitcnt lgkmcnt(8)
  v_mfma_f32_32x32x16_bf16 v[16:31], v[220:223], v[204:207], v[16:31]
  ds_read_b64_tr_b16 v[216:217], v13 offset:8192
  ds_read_b64_tr_b16 v[218:219], v13 offset:10240
  s_waitcnt lgkmcnt(8)
  v_mfma_f32_32x32x16_bf16 v[32:47], v[224:227], v[204:207], v[32:47]
  ds_read_b64_tr_b16 v[220:221], v13 offset:12288
  ds_read_b64_tr_b16 v[222:223], v13 offset:14336
  s_waitcnt lgkmcnt(8)
  v_mfma_f32_32x32x16_bf16 v[48:63], v[228:231], v[204:207], v[48:63]
  ds_read_b64_tr_b16 v[224:225], v13 offset:16384
  ds_read_b64_tr_b16 v[226:227], v13 offset:18432
  s_cmp_lg_u32 s48, 0
  s_cbranch_scc1 L_nob4b_117
  s_barrier
L_nob4b_117:
  ds_read_b128 v[232:235], v8 offset:0
  ds_read_b128 v[236:239], v8 offset:512
  ds_read_b128 v[240:243], v8 offset:32
  ds_read_b128 v[244:247], v8 offset:544
  s_waitcnt lgkmcnt(12)
  v_mfma_f32_32x32x16_bf16 v[64:79], v[208:211], v[80:83], 0
  ds_read_b64_tr_b16 v[228:229], v13 offset:20480
  ds_read_b64_tr_b16 v[230:231], v13 offset:22528
  s_nop 9
  s_waitcnt lgkmcnt(12)
  v_mfma_f32_32x32x16_bf16 v[64:79], v[212:215], v[84:87], v[64:79]
  ds_read_b64_tr_b16 v[208:209], v13 offset:24576
  ds_read_b64_tr_b16 v[210:211], v13 offset:26624
  s_waitcnt lgkmcnt(6)
  v_fma_f32 v16, v16, v4, v236
  v_fma_f32 v16, -v6, v232, v16
  v_fma_f32 v17, v17, v4, v237
  v_fma_f32 v17, -v6, v233, v17
  v_fma_f32 v18, v18, v4, v238
  v_fma_f32 v18, -v6, v234, v18
  v_fma_f32 v19, v19, v4, v239
  s_waitcnt lgkmcnt(12)
  v_mfma_f32_32x32x16_bf16 v[64:79], v[216:219], v[88:91], v[64:79]
  ds_read_b64_tr_b16 v[212:213], v13 offset:28672
  ds_read_b64_tr_b16 v[214:215], v13 offset:30720
  v_fma_f32 v19, -v6, v235, v19
  ds_read_b128 v[232:235], v8 offset:64
  ds_read_b128 v[236:239], v8 offset:576
  v_max_f32 v16, 0, v16
  v_mul_f32 v16, v16, v16
  v_max_f32 v17, 0, v17
  v_mul_f32 v17, v17, v17
  v_max_f32 v18, 0, v18
  v_mul_f32 v18, v18, v18
  s_waitcnt lgkmcnt(14)
  v_mfma_f32_32x32x16_bf16 v[64:79], v[220:223], v[92:95], v[64:79]
  ds_read_b64_tr_b16 v[216:217], v13 offset:32768
  ds_read_b64_tr_b16 v[218:219], v13 offset:34816
  v_max_f32 v19, 0, v19
  v_mul_f32 v19, v19, v19
  v_cvt_pk_bf16_f32 v16, v16, v17
  v_cvt_pk_bf16_f32 v17, v18, v19
  s_waitcnt lgkmcnt(10)
  v_fma_f32 v20, v20, v4, v244
  v_fma_f32 v20, -v6, v240, v20
  v_fma_f32 v21, v21, v4, v245
  s_waitcnt lgkmcnt(14)
  v_mfma_f32_32x32x16_bf16 v[64:79], v[224:227], v[96:99], v[64:79]
  ds_read_b64_tr_b16 v[220:221], v13 offset:36864
  ds_read_b64_tr_b16 v[222:223], v13 offset:38912
  v_fma_f32 v21, -v6, v241, v21
  v_fma_f32 v22, v22, v4, v246
  v_fma_f32 v22, -v6, v242, v22
  v_fma_f32 v23, v23, v4, v247
  v_fma_f32 v23, -v6, v243, v23
  ds_read_b128 v[240:243], v8 offset:96
  ds_read_b128 v[244:247], v8 offset:608
  v_max_f32 v20, 0, v20
  v_mul_f32 v20, v20, v20
  s_waitcnt lgkmcnt(12)
  v_mfma_f32_32x32x16_bf16 v[64:79], v[228:231], v[100:103], v[64:79]
  ds_read_b64_tr_b16 v[224:225], v13 offset:40960
  ds_read_b64_tr_b16 v[226:227], v13 offset:43008
  v_max_f32 v21, 0, v21
  v_mul_f32 v21, v21, v21
  v_max_f32 v22, 0, v22
  v_mul_f32 v22, v22, v22
  v_max_f32 v23, 0, v23
  v_mul_f32 v23, v23, v23
  v_cvt_pk_bf16_f32 v18, v20, v21
  s_waitcnt lgkmcnt(12)
  v_mfma_f32_32x32x16_bf16 v[64:79], v[208:211], v[104:107], v[64:79]
  ds_read_b64_tr_b16 v[228:229], v13 offset:45056
  ds_read_b64_tr_b16 v[230:231], v13 offset:47104
  v_cvt_pk_bf16_f32 v19, v22, v23
  s_waitcnt lgkmcnt(10)
  v_fma_f32 v24, v24, v4, v236
  v_fma_f32 v24, -v6, v232, v24
  v_fma_f32 v25, v25, v4, v237
  v_fma_f32 v25, -v6, v233, v25
  v_fma_f32 v26, v26, v4, v238
  v_fma_f32 v26, -v6, v234, v26
  s_waitcnt lgkmcnt(12)
  v_mfma_f32_32x32x16_bf16 v[64:79], v[212:215], v[108:111], v[64:79]
  ds_read_b64_tr_b16 v[208:209], v13 offset:49152
  ds_read_b64_tr_b16 v[210:211], v13 offset:51200
  v_fma_f32 v27, v27, v4, v239
  v_fma_f32 v27, -v6, v235, v27
  ds_read_b128 v[232:235], v8 offset:128
  ds_read_b128 v[236:239], v8 offset:640
  v_max_f32 v24, 0, v24
  v_mul_f32 v24, v24, v24
  v_max_f32 v25, 0, v25
  v_mul_f32 v25, v25, v25
  v_max_f32 v26, 0, v26
  s_waitcnt lgkmcnt(12)
  v_mfma_f32_32x32x16_bf16 v[64:79], v[216:219], v[112:115], v[64:79]
  ds_read_b64_tr_b16 v[212:213], v13 offset:53248
  ds_read_b64_tr_b16 v[214:215], v13 offset:55296
  v_mul_f32 v26, v26, v26
  v_max_f32 v27, 0, v27
  v_mul_f32 v27, v27, v27
  v_cvt_pk_bf16_f32 v20, v24, v25
  v_cvt_pk_bf16_f32 v21, v26, v27
  s_waitcnt lgkmcnt(10)
  v_fma_f32 v28, v28, v4, v244
  v_fma_f32 v28, -v6, v240, v28
  s_waitcnt lgkmcnt(12)
  v_mfma_f32_32x32x16_bf16 v[64:79], v[220:223], v[116:119], v[64:79]
  ds_read_b64_tr_b16 v[216:217], v13 offset:57344
  ds_read_b64_tr_b16 v[218:219], v13 offset:59392
  v_fma_f32 v29, v29, v4, v245
  v_fma_f32 v29, -v6, v241, v29
  v_fma_f32 v30, v30, v4, v246
  v_fma_f32 v30, -v6, v242, v30
  v_fma_f32 v31, v31, v4, v247
  v_fma_f32 v31, -v6, v243, v31
  ds_read_b128 v[240:243], v8 offset:160
  ds_read_b128 v[244:247], v8 offset:672
  v_max_f32 v28, 0, v28
  s_waitcnt lgkmcnt(12)
  v_mfma_f32_32x32x16_bf16 v[64:79], v[224:227], v[120:123], v[64:79]
  ds_read_b64_tr_b16 v[220:221], v13 offset:61440
  ds_read_b64_tr_b16 v[222:223], v13 offset:63488
  v_mul_f32 v28, v28, v28
  v_max_f32 v29, 0, v29
  v_mul_f32 v29, v29, v29
  v_max_f32 v30, 0, v30
  v_mul_f32 v30, v30, v30
  v_max_f32 v31, 0, v31
  v_mul_f32 v31, v31, v31
  s_waitcnt lgkmcnt(12)
  v_mfma_f32_32x32x16_bf16 v[64:79], v[228:231], v[124:127], v[64:79]
  v_add_u32 v13, 65536, v13
  ds_read_b64_tr_b16 v[224:225], v13 offset:0
  ds_read_b64_tr_b16 v[226:227], v13 offset:2048
  v_cvt_pk_bf16_f32 v22, v28, v29
  v_cvt_pk_bf16_f32 v23, v30, v31
  s_cmp_eq_u32 s47, 1
  s_cbranch_scc1 L_fast_118
  buffer_store_dwordx4 v[16:19], v1, s[8:11], s52 offen offset:0 sc1
  buffer_store_dwordx4 v[20:23], v1, s[8:11], s52 offen offset:1024 sc1
  s_branch L_join_119
L_fast_118:
  buffer_store_dwordx4 v[16:19], v1, s[8:11], s52 offen offset:0
  buffer_store_dwordx4 v[20:23], v1, s[8:11], s52 offen offset:1024
L_join_119:
  s_waitcnt lgkmcnt(10)
  v_fma_f32 v32, v32, v4, v236
  v_fma_f32 v32, -v6, v232, v32
  v_fma_f32 v33, v33, v4, v237
  v_fma_f32 v33, -v6, v233, v33
  v_fma_f32 v34, v34, v4, v238
  s_waitcnt lgkmcnt(12)
  v_mfma_f32_32x32x16_bf16 v[64:79], v[208:211], v[128:131], v[64:79]
  ds_read_b64_tr_b16 v[228:229], v13 offset:4096
  ds_read_b64_tr_b16 v[230:231], v13 offset:6144
  v_fma_f32 v34, -v6, v234, v34
  v_fma_f32 v35, v35, v4, v239
  v_fma_f32 v35, -v6, v235, v35
  ds_read_b128 v[232:235], v8 offset:192
  ds_read_b128 v[236:239], v8 offset:704
  v_max_f32 v32, 0, v32
  v_mul_f32 v32, v32, v32
  v_max_f32 v33, 0, v33
  v_mul_f32 v33, v33, v33
  s_waitcnt lgkmcnt(12)
  v_mfma_f32_32x32x16_bf16 v[64:79], v[212:215], v[132:135], v[64:79]
  ds_read_b64_tr_b16 v[208:209], v13 offset:8192
  ds_read_b64_tr_b16 v[210:211], v13 offset:10240
  v_max_f32 v34, 0, v34
  v_mul_f32 v34, v34, v34
  v_max_f32 v35, 0, v35
  v_mul_f32 v35, v35, v35
  v_cvt_pk_bf16_f32 v32, v32, v33
  v_cvt_pk_bf16_f32 v33, v34, v35
  s_waitcnt lgkmcnt(10)
  v_fma_f32 v36, v36, v4, v244
  s_waitcnt lgkmcnt(12)
  v_mfma_f32_32x32x16_bf16 v[64:79], v[216:219], v[136:139], v[64:79]
  ds_read_b64_tr_b16 v[212:213], v13 offset:12288
  ds_read_b64_tr_b16 v[214:215], v13 offset:14336
  v_fma_f32 v36, -v6, v240, v36
  v_fma_f32 v37, v37, v4, v245
  v_fma_f32 v37, -v6, v241, v37
  v_fma_f32 v38, v38, v4, v246
  v_fma_f32 v38, -v6, v242, v38
  v_fma_f32 v39, v39, v4, v247
  v_fma_f32 v39, -v6, v243, v39
  s_waitcnt lgkmcnt(10)
  v_mfma_f32_32x32x16_bf16 v[64:79], v[220:223], v[140:143], v[64:79]
  ds_read_b64_tr_b16 v[216:217], v13 offset:16384
  ds_read_b64_tr_b16 v[218:219], v13 offset:18432
  ds_read_b128 v[240:243], v8 offset:224
  ds_read_b128 v[244:247], v8 offset:736
  v_max_f32 v36, 0, v36
  v_mul_f32 v36, v36, v36
  v_max_f32 v37, 0, v37
  v_mul_f32 v37, v37, v37
  v_max_f32 v38, 0, v38
  v_mul_f32 v38, v38, v38
  v_max_f32 v39, 0, v39
  s_waitcnt lgkmcnt(12)
  v_mfma_f32_32x32x16_bf16 v[64:79], v[224:227], v[144:147], v[64:79]
  ds_read_b64_tr_b16 v[220:221], v13 offset:20480
  ds_read_b64_tr_b16 v[222:223], v13 offset:22528
  v_mul_f32 v39, v39, v39
  v_cvt_pk_bf16_f32 v34, v36, v37
  v_cvt_pk_bf16_f32 v35, v38, v39
  s_waitcnt lgkmcnt(10)
  v_fma_f32 v40, v40, v4, v236
  v_fma_f32 v40, -v6, v232, v40
  v_fma_f32 v41, v41, v4, v237
  v_fma_f32 v41, -v6, v233, v41
  s_waitcnt lgkmcnt(12)
  v_mfma_f32_32x32x16_bf16 v[64:79], v[228:231], v[148:151], v[64:79]
  ds_read_b64_tr_b16 v[224:225], v13 offset:24576
  ds_read_b64_tr_b16 v[226:227], v13 offset:26624
  v_fma_f32 v42, v42, v4, v238
  v_fma_f32 v42, -v6, v234, v42
  v_fma_f32 v43, v43, v4, v239
  v_fma_f32 v43, -v6, v235, v43
  ds_read_b128 v[232:235], v8 offset:256
  ds_read_b128 v[236:239], v8 offset:768
  v_max_f32 v40, 0, v40
  v_mul_f32 v40, v40, v40
  v_max_f32 v41, 0, v41
  s_waitcnt lgkmcnt(12)
  v_mfma_f32_32x32x16_bf16 v[64:79], v[208:211], v[152:155], v[64:79]
  ds_read_b64_tr_b16 v[228:229], v13 offset:28672
  ds_read_b64_tr_b16 v[230:231], v13 offset:30720
  v_mul_f32 v41, v41, v41
  v_max_f32 v42, 0, v42
  v_mul_f32 v42, v42, v42
  v_max_f32 v43, 0, v43
  v_mul_f32 v43, v43, v43
  v_cvt_pk_bf16_f32 v36, v40, v41
  v_cvt_pk_bf16_f32 v37, v42, v43
  s_waitcnt lgkmcnt(12)
  v_mfma_f32_32x32x16_bf16 v[64:79], v[212:215], v[156:159], v[64:79]
  ds_read_b64_tr_b16 v[208:209], v13 offset:32768
  ds_read_b64_tr_b16 v[210:211], v13 offset:34816
  s_waitcnt lgkmcnt(10)
  v_fma_f32 v44, v44, v4, v244
  v_fma_f32 v44, -v6, v240, v44
  v_fma_f32 v45, v45, v4, v245
  v_fma_f32 v45, -v6, v241, v45
  v_fma_f32 v46, v46, v4, v246
  v_fma_f32 v46, -v6, v242, v46
  v_fma_f32 v47, v47, v4, v247
  s_waitcnt lgkmcnt(12)
  v_mfma_f32_32x32x16_bf16 v[64:79], v[216:219], v[160:163], v[64:79]
  ds_read_b64_tr_b16 v[212:213], v13 offset:36864
  ds_read_b64_tr_b16 v[214:215], v13 offset:38912
  v_fma_f32 v47, -v6, v243, v47
  ds_read_b128 v[240:243], v8 offset:288
  ds_read_b128 v[244:247], v8 offset:800
  v_max_f32 v44, 0, v44
  v_mul_f32 v44, v44, v44
  v_max_f32 v45, 0, v45
  v_mul_f32 v45, v45, v45
  v_max_f32 v46, 0, v46
  v_mul_f32 v46, v46, v46
  s_waitcnt lgkmcnt(12)
  v_mfma_f32_32x32x16_bf16 v[64:79], v[220:223], v[164:167], v[64:79]
  ds_read_b64_tr_b16 v[216:217], v13 offset:40960
  ds_read_b64_tr_b16 v[218:219], v13 offset:43008
  v_max_f32 v47, 0, v47
  v_mul_f32 v47, v47, v47
  v_cvt_pk_bf16_f32 v38, v44, v45
  v_cvt_pk_bf16_f32 v39, v46, v47
  s_cmp_eq_u32 s47, 1
  s_cbranch_scc1 L_fast_120
  buffer_store_dwordx4 v[32:35], v1, s[8:11], s52 offen offset:2048 sc1
  buffer_store_dwordx4 v[36:39], v1, s[8:11], s52 offen offset:3072 sc1
  s_branch L_join_121
L_fast_120:
  buffer_store_dwordx4 v[32:35], v1, s[8:11], s52 offen offset:2048
  buffer_store_dwordx4 v[36:39], v1, s[8:11], s52 offen offset:3072
L_join_121:
  s_waitcnt lgkmcnt(10)
  v_fma_f32 v48, v48, v4, v236
  v_fma_f32 v48, -v6, v232, v48
  v_fma_f32 v49, v49, v4, v237
  s_waitcnt lgkmcnt(12)
  v_mfma_f32_32x32x16_bf16 v[64:79], v[224:227], v[168:171], v[64:79]
  ds_read_b64_tr_b16 v[220:221], v13 offset:45056
  ds_read_b64_tr_b16 v[222:223], v13 offset:47104
  v_fma_f32 v49, -v6, v233, v49
  v_fma_f32 v50, v50, v4, v238
  v_fma_f32 v50, -v6, v234, v50
  v_fma_f32 v51, v51, v4, v239
  v_fma_f32 v51, -v6, v235, v51
  ds_read_b128 v[232:235], v8 offset:320
  ds_read_b128 v[236:239], v8 offset:832
  v_max_f32 v48, 0, v48
  v_mul_f32 v48, v48, v48
  s_waitcnt lgkmcnt(12)
  v_mfma_f32_32x32x16_bf16 v[64:79], v[228:231], v[172:175], v[64:79]
  ds_read_b64_tr_b16 v[224:225], v13 offset:49152
  ds_read_b64_tr_b16 v[226:227], v13 offset:51200
  v_max_f32 v49, 0, v49
  v_mul_f32 v49, v49, v49
  v_max_f32 v50, 0, v50
  v_mul_f32 v50, v50, v50
  v_max_f32 v51, 0, v51
  v_mul_f32 v51, v51, v51
  v_cvt_pk_bf16_f32 v48, v48, v49
  s_waitcnt lgkmcnt(12)
  v_mfma_f32_32x32x16_bf16 v[64:79], v[208:211], v[176:179], v[64:79]
  ds_read_b64_tr_b16 v[228:229], v13 offset:53248
  ds_read_b64_tr_b16 v[230:231], v13 offset:55296
  v_cvt_pk_bf16_f32 v49, v50, v51
  s_waitcnt lgkmcnt(10)
  v_fma_f32 v52, v52, v4, v244
  v_fma_f32 v52, -v6, v240, v52
  v_fma_f32 v53, v53, v4, v245
  v_fma_f32 v53, -v6, v241, v53
  v_fma_f32 v54, v54, v4, v246
  v_fma_f32 v54, -v6, v242, v54
  s_waitcnt lgkmcnt(12)
  v_mfma_f32_32x32x16_bf16 v[64:79], v[212:215], v[180:183], v[64:79]
  ds_read_b64_tr_b16 v[208:209], v13 offset:57344
  ds_read_b64_tr_b16 v[210:211], v13 offset:59392
  v_fma_f32 v55, v55, v4, v247
  v_fma_f32 v55, -v6, v243, v55
  ds_read_b128 v[240:243], v8 offset:352
  ds_read_b128 v[244:247], v8 offset:864
  v_max_f32 v52, 0, v52
  v_mul_f32 v52, v52, v52
  v_max_f32 v53, 0, v53
  v_mul_f32 v53, v53, v53
  v_max_f32 v54, 0, v54
  s_waitcnt lgkmcnt(12)
  v_mfma_f32_32x32x16_bf16 v[64:79], v[216:219], v[184:187], v[64:79]
  ds_read_b64_tr_b16 v[212:213], v13 offset:61440
  ds_read_b64_tr_b16 v[214:215], v13 offset:63488
  v_mul_f32 v54, v54, v54
  v_max_f32 v55, 0, v55
  v_mul_f32 v55, v55, v55
  v_cvt_pk_bf16_f32 v50, v52, v53
  v_cvt_pk_bf16_f32 v51, v54, v55
  s_waitcnt lgkmcnt(10)
  v_fma_f32 v56, v56, v4, v236
  v_fma_f32 v56, -v6, v232, v56
  s_waitcnt lgkmcnt(12)
  v_mfma_f32_32x32x16_bf16 v[64:79], v[220:223], v[188:191], v[64:79]
  v_fma_f32 v57, v57, v4, v237
  v_fma_f32 v57, -v6, v233, v57
  v_fma_f32 v58, v58, v4, v238
  v_fma_f32 v58, -v6, v234, v58
  v_fma_f32 v59, v59, v4, v239
  v_fma_f32 v59, -v6, v235, v59
  ds_read_b128 v[232:235], v8 offset:384
  ds_read_b128 v[236:239], v8 offset:896
  v_max_f32 v56, 0, v56
  s_waitcnt lgkmcnt(10)
  v_mfma_f32_32x32x16_bf16 v[64:79], v[224:227], v[192:195], v[64:79]
  v_mul_f32 v56, v56, v56
  v_max_f32 v57, 0, v57
  v_mul_f32 v57, v57, v57
  v_max_f32 v58, 0, v58
  v_mul_f32 v58, v58, v58
  v_max_f32 v59, 0, v59
  v_mul_f32 v59, v59, v59
  s_waitcnt lgkmcnt(8)
  v_mfma_f32_32x32x16_bf16 v[64:79], v[228:231], v[196:199], v[64:79]
  v_cvt_pk_bf16_f32 v52, v56, v57
  v_cvt_pk_bf16_f32 v53, v58, v59
  s_waitcnt lgkmcnt(4)
  v_fma_f32 v60, v60, v4, v244
  v_fma_f32 v60, -v6, v240, v60
  v_fma_f32 v61, v61, v4, v245
  v_fma_f32 v61, -v6, v241, v61
  v_fma_f32 v62, v62, v4, v246
  s_waitcnt lgkmcnt(6)
  v_mfma_f32_32x32x16_bf16 v[64:79], v[208:211], v[200:203], v[64:79]
  v_fma_f32 v62, -v6, v242, v62
  v_fma_f32 v63, v63, v4, v247
  v_fma_f32 v63, -v6, v243, v63
  ds_read_b128 v[240:243], v8 offset:416
  ds_read_b128 v[244:247], v8 offset:928
  v_max_f32 v60, 0, v60
  v_mul_f32 v60, v60, v60
  v_max_f32 v61, 0, v61
  v_mul_f32 v61, v61, v61
  s_waitcnt lgkmcnt(4)
  v_mfma_f32_32x32x16_bf16 v[64:79], v[212:215], v[204:207], v[64:79]
  v_max_f32 v62, 0, v62
  v_mul_f32 v62, v62, v62
  v_max_f32 v63, 0, v63
  v_mul_f32 v63, v63, v63
  v_cvt_pk_bf16_f32 v54, v60, v61
  v_cvt_pk_bf16_f32 v55, v62, v63
  s_add_u32 s52, s52, 4096
  s_cmp_eq_u32 s47, 1
  s_cbranch_scc1 L_fast_122
  buffer_store_dwordx4 v[48:51], v1, s[8:11], s52 offen offset:0 sc1
  buffer_store_dwordx4 v[52:55], v1, s[8:11], s52 offen offset:1024 sc1
  s_branch L_join_123
L_fast_122:
  buffer_store_dwordx4 v[48:51], v1, s[8:11], s52 offen offset:0
  buffer_store_dwordx4 v[52:55], v1, s[8:11], s52 offen offset:1024
L_join_123:
  s_barrier
  s_waitcnt lgkmcnt(2)
  s_nop 7
  v_pk_fma_f32 v[64:65], v[64:65], v[4:5], v[236:237] op_sel_hi:[1,0,1]
  v_pk_fma_f32 v[64:65], v[232:233], v[6:7], v[64:65] op_sel_hi:[1,0,1] neg_lo:[0,1,0] neg_hi:[0,1,0]
  v_pk_fma_f32 v[66:67], v[66:67], v[4:5], v[238:239] op_sel_hi:[1,0,1]
  v_pk_fma_f32 v[66:67], v[234:235], v[6:7], v[66:67] op_sel_hi:[1,0,1] neg_lo:[0,1,0] neg_hi:[0,1,0]
  ds_read_b128 v[232:235], v8 offset:448
  ds_read_b128 v[236:239], v8 offset:960
  v_max_f32 v64, 0, v64
  v_max_f32 v65, 0, v65
  v_pk_mul_f32 v[64:65], v[64:65], v[64:65]
  v_max_f32 v66, 0, v66
  v_max_f32 v67, 0, v67
  v_pk_mul_f32 v[66:67], v[66:67], v[66:67]
  v_cvt_pk_bf16_f32 v64, v64, v65
  v_cvt_pk_bf16_f32 v65, v66, v67
  s_waitcnt lgkmcnt(2)
  v_pk_fma_f32 v[68:69], v[68:69], v[4:5], v[244:245] op_sel_hi:[1,0,1]
  v_pk_fma_f32 v[68:69], v[240:241], v[6:7], v[68:69] op_sel_hi:[1,0,1] neg_lo:[0,1,0] neg_hi:[0,1,0]
  v_pk_fma_f32 v[70:71], v[70:71], v[4:5], v[246:247] op_sel_hi:[1,0,1]
  v_pk_fma_f32 v[70:71], v[242:243], v[6:7], v[70:71] op_sel_hi:[1,0,1] neg_lo:[0,1,0] neg_hi:[0,1,0]
  ds_read_b128 v[240:243], v8 offset:480
  ds_read_b128 v[244:247], v8 offset:992
  v_max_f32 v68, 0, v68
  v_max_f32 v69, 0, v69
  v_pk_mul_f32 v[68:69], v[68:69], v[68:69]
  v_max_f32 v70, 0, v70
  v_max_f32 v71, 0, v71
  v_pk_mul_f32 v[70:71], v[70:71], v[70:71]
  v_cvt_pk_bf16_f32 v66, v68, v69
  v_cvt_pk_bf16_f32 v67, v70, v71
  s_waitcnt lgkmcnt(2)
  v_pk_fma_f32 v[72:73], v[72:73], v[4:5], v[236:237] op_sel_hi:[1,0,1]
  v_pk_fma_f32 v[72:73], v[232:233], v[6:7], v[72:73] op_sel_hi:[1,0,1] neg_lo:[0,1,0] neg_hi:[0,1,0]
  v_pk_fma_f32 v[74:75], v[74:75], v[4:5], v[238:239] op_sel_hi:[1,0,1]
  v_pk_fma_f32 v[74:75], v[234:235], v[6:7], v[74:75] op_sel_hi:[1,0,1] neg_lo:[0,1,0] neg_hi:[0,1,0]
  v_max_f32 v72, 0, v72
  v_max_f32 v73, 0, v73
  v_pk_mul_f32 v[72:73], v[72:73], v[72:73]
  v_max_f32 v74, 0, v74
  v_max_f32 v75, 0, v75
  v_pk_mul_f32 v[74:75], v[74:75], v[74:75]
  v_cvt_pk_bf16_f32 v68, v72, v73
  v_cvt_pk_bf16_f32 v69, v74, v75
  s_waitcnt lgkmcnt(0)
  v_pk_fma_f32 v[76:77], v[76:77], v[4:5], v[244:245] op_sel_hi:[1,0,1]
  v_pk_fma_f32 v[76:77], v[240:241], v[6:7], v[76:77] op_sel_hi:[1,0,1] neg_lo:[0,1,0] neg_hi:[0,1,0]
  v_pk_fma_f32 v[78:79], v[78:79], v[4:5], v[246:247] op_sel_hi:[1,0,1]
  v_pk_fma_f32 v[78:79], v[242:243], v[6:7], v[78:79] op_sel_hi:[1,0,1] neg_lo:[0,1,0] neg_hi:[0,1,0]
  v_max_f32 v76, 0, v76
  v_max_f32 v77, 0, v77
  v_pk_mul_f32 v[76:77], v[76:77], v[76:77]
  v_max_f32 v78, 0, v78
  v_max_f32 v79, 0, v79
  v_pk_mul_f32 v[78:79], v[78:79], v[78:79]
  v_cvt_pk_bf16_f32 v70, v76, v77
  v_cvt_pk_bf16_f32 v71, v78, v79
  s_cmp_eq_u32 s47, 1
  s_cbranch_scc1 L_fast_124
  buffer_store_dwordx4 v[64:67], v1, s[8:11], s52 offen offset:2048 sc1
  buffer_store_dwordx4 v[68:71], v1, s[8:11], s52 offen offset:3072 sc1
  s_branch L_join_125
L_fast_124:
  buffer_store_dwordx4 v[64:67], v1, s[8:11], s52 offen offset:2048
  buffer_store_dwordx4 v[68:71], v1, s[8:11], s52 offen offset:3072
L_join_125:
  s_waitcnt vmcnt(0)
  s_branch L_p4end_114
L_p4idle_113:
  s_barrier
  s_cmp_lg_u32 s48, 0
  s_cbranch_scc1 L_nob4bi_126
  s_barrier
L_nob4bi_126:
  s_barrier
L_p4end_114:
  s_lshl_b32 s52, s48, 2
  s_add_u32 s52, s52, 3
  v_mov_b32 v4, s52
  v_mov_b32 v5, 0
  s_mov_b64 exec, 1
  s_cmp_eq_u32 s47, 1
  s_cbranch_scc1 L_fast_127
  buffer_store_dword v4, v5, s[8:11], s50 offen sc1
  s_branch L_join_128
L_fast_127:
  buffer_store_dword v4, v5, s[8:11], s50 offen
L_join_128:
  s_mov_b64 exec, -1
  v_lshrrev_b32 v7, 5, v0
  v_lshlrev_b32 v7, 4, v7
  s_lshr_b32 s52, s46, 1
  s_lshl_b32 s52, s52, 7
  s_add_u32 s52, s52, 163328
  v_add_u32 v7, s52, v7
  ds_read_b128 v[32:35], v7 offset:0
  ds_read_b128 v[36:39], v7 offset:32
  ds_read_b128 v[40:43], v7 offset:64
  ds_read_b128 v[44:47], v7 offset:96
  s_waitcnt lgkmcnt(0)
  v_lshlrev_b32 v48, 16, v248
  v_and_b32 v49, 0xffff0000, v248
  v_lshlrev_b32 v50, 16, v249
  v_and_b32 v51, 0xffff0000, v249
  v_lshlrev_b32 v52, 16, v250
  v_and_b32 v53, 0xffff0000, v250
  v_lshlrev_b32 v54, 16, v251
  v_and_b32 v55, 0xffff0000, v251
  v_lshlrev_b32 v56, 16, v252
  v_and_b32 v57, 0xffff0000, v252
  v_lshlrev_b32 v58, 16, v253
  v_and_b32 v59, 0xffff0000, v253
  v_lshlrev_b32 v60, 16, v254
  v_and_b32 v61, 0xffff0000, v254
  v_lshlrev_b32 v62, 16, v255
  v_and_b32 v63, 0xffff0000, v255
  v_pk_add_f32 v[48:49], v[48:49], v[32:33]
  v_pk_add_f32 v[50:51], v[50:51], v[34:35]
  v_pk_add_f32 v[52:53], v[52:53], v[36:37]
  v_pk_add_f32 v[54:55], v[54:55], v[38:39]
  v_pk_add_f32 v[56:57], v[56:57], v[40:41]
  v_pk_add_f32 v[58:59], v[58:59], v[42:43]
  v_pk_add_f32 v[60:61], v[60:61], v[44:45]
  v_pk_add_f32 v[62:63], v[62:63], v[46:47]
  s_lshl_b32 s90, s48, 2
  s_add_u32 s90, s90, 3
  v_lshlrev_b32 v4, 2, v0
  s_mov_b32 s91, 262144
  s_cmp_eq_u32 s51, 0
  s_cbranch_scc0 L_pdone_130
L_poll_129:
  buffer_load_dword v5, v4, s[8:11], s49 offen sc1
  s_waitcnt vmcnt(0)
  v_cmp_gt_u32 vcc, s90, v5
  s_cbranch_vccz L_pdone_130
  s_sleep 1
  s_sub_u32 s91, s91, 1
  s_cbranch_scc0 L_poll_129
  s_mov_b32 s51, 1
L_pdone_130:
  s_lshl_b32 s56, s44, 2
  s_lshr_b32 s53, s45, 3
  s_lshl_b32 s53, s53, 1
  s_add_u32 s56, s56, s53
  s_and_b32 s53, s46, 1
  s_add_u32 s56, s56, s53
  s_lshr_b32 s55, s46, 1
  s_mul_i32 s54, s55, 56
  s_mul_i32 s61, s56, 114688
  s_add_u32 s61, s61, 16777216
  s_lshl_b32 s59, s54, 10
  s_add_u32 s61, s61, s59
  buffer_load_dwordx4 v[64:67], v1, s[8:11], s61 offen offset:0 sc1
  buffer_load_dwordx4 v[68:71], v1, s[8:11], s61 offen offset:1024 sc1
  buffer_load_dwordx4 v[72:75], v1, s[8:11], s61 offen offset:2048 sc1
  buffer_load_dwordx4 v[76:79], v1, s[8:11], s61 offen offset:3072 sc1
  s_add_u32 s61, s61, 4096
  buffer_load_dwordx4 v[80:83], v1, s[8:11], s61 offen offset:0 sc1
  buffer_load_dwordx4 v[84:87], v1, s[8:11], s61 offen offset:1024 sc1
  buffer_load_dwordx4 v[88:91], v1, s[8:11], s61 offen offset:2048 sc1
  buffer_load_dwordx4 v[92:95], v1, s[8:11], s61 offen offset:3072 sc1
  s_add_u32 s61, s61, 4096
  buffer_load_dwordx4 v[96:99], v1, s[8:11], s61 offen offset:0 sc1
  buffer_load_dwordx4 v[100:103], v1, s[8:11], s61 offen offset:1024 sc1
  buffer_load_dwordx4 v[104:107], v1, s[8:11], s61 offen offset:2048 sc1
  buffer_load_dwordx4 v[108:111], v1, s[8:11], s61 offen offset:3072 sc1
  s_lshl_b32 s60, s55, 14
  v_lshrrev_b32 v4, 5, v0
  v_lshlrev_b32 v4, 2, v4
  v_bfe_u32 v6, v0, 2, 2
  v_add_u32 v4, v4, v6
  v_bfe_u32 v5, v0, 4, 1
  v_lshlrev_b32 v5, 5, v5
  v_and_b32 v6, 3, v0
  v_lshlrev_b32 v6, 3, v6
  v_add_u32 v5, v5, v6
  v_bfe_u32 v6, v4, 1, 1
  v_lshl_add_u32 v5, v4, 7, v5
  s_lshr_b32 s55, s46, 1
  v_xor_b32 v6, s55, v6
  v_lshl_add_u32 v4, v6, 6, v5
  v_xor_b32 v6, 1, v6
  v_lshl_add_u32 v5, v6, 6, v5
  v_add_u32 v4, s60, v4
  v_add_u32 v5, s60, v5
  v_add_u32 v8, 65536, v4
  v_add_u32 v9, 65536, v5
  s_barrier
  ds_read_b64_tr_b16 v[176:177], v4 offset:0
  ds_read_b64_tr_b16 v[178:179], v4 offset:1024
  ds_read_b64_tr_b16 v[180:181], v5 offset:0
  ds_read_b64_tr_b16 v[182:183], v5 offset:1024
  ds_read_b64_tr_b16 v[184:185], v4 offset:2048
  ds_read_b64_tr_b16 v[186:187], v4 offset:3072
  ds_read_b64_tr_b16 v[188:189], v5 offset:2048
  ds_read_b64_tr_b16 v[190:191], v5 offset:3072
  s_waitcnt vmcnt(11)
  ds_read_b64_tr_b16 v[192:193], v4 offset:4096
  ds_read_b64_tr_b16 v[194:195], v4 offset:5120
  ds_read_b64_tr_b16 v[196:197], v5 offset:4096
  ds_read_b64_tr_b16 v[198:199], v5 offset:5120
  s_waitcnt lgkmcnt(8)
  v_mfma_f32_32x32x16_bf16 v[16:31], v[176:179], v[64:67], v[48:63]
  v_mfma_f32_32x32x16_bf16 v[32:47], v[180:183], v[64:67], 0
  s_add_u32 s61, s61, 4096
  buffer_load_dwordx4 v[64:67], v1, s[8:11], s61 offen offset:0 sc1
  s_waitcnt vmcnt(11)
  ds_read_b64_tr_b16 v[176:177], v4 offset:6144
  ds_read_b64_tr_b16 v[178:179], v4 offset:7168
  ds_read_b64_tr_b16 v[180:181], v5 offset:6144
  ds_read_b64_tr_b16 v[182:183], v5 offset:7168
  s_waitcnt lgkmcnt(8)
  v_mfma_f32_32x32x16_bf16 v[16:31], v[184:187], v[68:71], v[16:31]
  v_mfma_f32_32x32x16_bf16 v[32:47], v[188:191], v[68:71], v[32:47]
  buffer_load_dwordx4 v[68:71], v1, s[8:11], s61 offen offset:1024 sc1
  s_waitcnt vmcnt(11)
  ds_read_b64_tr_b16 v[184:185], v4 offset:8192
  ds_read_b64_tr_b16 v[186:187], v4 offset:9216
  ds_read_b64_tr_b16 v[188:189], v5 offset:8192
  ds_read_b64_tr_b16 v[190:191], v5 offset:9216
  s_waitcnt lgkmcnt(8)
  v_mfma_f32_32x32x16_bf16 v[16:31], v[192:195], v[72:75], v[16:31]
  v_mfma_f32_32x32x16_bf16 v[32:47], v[196:199], v[72:75], v[32:47]
  buffer_load_dwordx4 v[72:75], v1, s[8:11], s61 offen offset:2048 sc1
  s_waitcnt vmcnt(11)
  ds_read_b64_tr_b16 v[192:193], v4 offset:10240
  ds_read_b64_tr_b16 v[194:195], v4 offset:11264
  ds_read_b64_tr_b16 v[196:197], v5 offset:10240
  ds_read_b64_tr_b16 v[198:199], v5 offset:11264
  s_waitcnt lgkmcnt(8)
  v_mfma_f32_32x32x16_bf16 v[16:31], v[176:179], v[76:79], v[16:31]
  v_mfma_f32_32x32x16_bf16 v[32:47], v[180:183], v[76:79], v[32:47]
  buffer_load_dwordx4 v[76:79], v1, s[8:11], s61 offen offset:3072 sc1
  s_waitcnt vmcnt(11)
  ds_read_b64_tr_b16 v[176:177], v4 offset:12288
  ds_read_b64_tr_b16 v[178:179], v4 offset:13312
  ds_read_b64_tr_b16 v[180:181], v5 offset:12288
  ds_read_b64_tr_b16 v[182:183], v5 offset:13312
  s_waitcnt lgkmcnt(8)
  v_mfma_f32_32x32x16_bf16 v[16:31], v[184:187], v[80:83], v[16:31]
  v_mfma_f32_32x32x16_bf16 v[32:47], v[188:191], v[80:83], v[32:47]
  s_add_u32 s61, s61, 4096
  buffer_load_dwordx4 v[80:83], v1, s[8:11], s61 offen offset:0 sc1
  s_waitcnt vmcnt(11)
  ds_read_b64_tr_b16 v[184:185], v4 offset:14336
  ds_read_b64_tr_b16 v[186:187], v4 offset:15360
  ds_read_b64_tr_b16 v[188:189], v5 offset:14336
  ds_read_b64_tr_b16 v[190:191], v5 offset:15360
  s_waitcnt lgkmcnt(8)
  v_mfma_f32_32x32x16_bf16 v[16:31], v[192:195], v[84:87], v[16:31]
  v_mfma_f32_32x32x16_bf16 v[32:47], v[196:199], v[84:87], v[32:47]
  buffer_load_dwordx4 v[84:87], v1, s[8:11], s61 offen offset:1024 sc1
  s_waitcnt vmcnt(11)
  s_barrier
  ds_read_b64_tr_b16 v[192:193], v4 offset:32768
  ds_read_b64_tr_b16 v[194:195], v4 offset:33792
  ds_read_b64_tr_b16 v[196:197], v5 offset:32768
  ds_read_b64_tr_b16 v[198:199], v5 offset:33792
  s_waitcnt lgkmcnt(8)
  v_mfma_f32_32x32x16_bf16 v[16:31], v[176:179], v[88:91], v[16:31]
  v_mfma_f32_32x32x16_bf16 v[32:47], v[180:183], v[88:91], v[32:47]
  buffer_load_dwordx4 v[88:91], v1, s[8:11], s61 offen offset:2048 sc1
  s_waitcnt vmcnt(11)
  ds_read_b64_tr_b16 v[176:177], v4 offset:34816
  ds_read_b64_tr_b16 v[178:179], v4 offset:35840
  ds_read_b64_tr_b16 v[180:181], v5 offset:34816
  ds_read_b64_tr_b16 v[182:183], v5 offset:35840
  s_waitcnt lgkmcnt(8)
  v_mfma_f32_32x32x16_bf16 v[16:31], v[184:187], v[92:95], v[16:31]
  v_mfma_f32_32x32x16_bf16 v[32:47], v[188:191], v[92:95], v[32:47]
  buffer_load_dwordx4 v[92:95], v1, s[8:11], s61 offen offset:3072 sc1
  s_waitcnt vmcnt(11)
  ds_read_b64_tr_b16 v[184:185], v4 offset:36864
  ds_read_b64_tr_b16 v[186:187], v4 offset:37888
  ds_read_b64_tr_b16 v[188:189], v5 offset:36864
  ds_read_b64_tr_b16 v[190:191], v5 offset:37888
  s_waitcnt lgkmcnt(8)
  v_mfma_f32_32x32x16_bf16 v[16:31], v[192:195], v[96:99], v[16:31]
  v_mfma_f32_32x32x16_bf16 v[32:47], v[196:199], v[96:99], v[32:47]
  s_add_u32 s61, s61, 4096
  buffer_load_dwordx4 v[96:99], v1, s[8:11], s61 offen offset:0 sc1
  s_waitcnt vmcnt(11)
  ds_read_b64_tr_b16 v[192:193], v4 offset:38912
  ds_read_b64_tr_b16 v[194:195], v4 offset:39936
  ds_read_b64_tr_b16 v[196:197], v5 offset:38912
  ds_read_b64_tr_b16 v[198:199], v5 offset:39936
  s_waitcnt lgkmcnt(8)
  v_mfma_f32_32x32x16_bf16 v[16:31], v[176:179], v[100:103], v[16:31]
  v_mfma_f32_32x32x16_bf16 v[32:47], v[180:183], v[100:103], v[32:47]
  buffer_load_dwordx4 v[100:103], v1, s[8:11], s61 offen offset:1024 sc1
  s_waitcnt vmcnt(11)
  ds_read_b64_tr_b16 v[176:177], v4 offset:40960
  ds_read_b64_tr_b16 v[178:179], v4 offset:41984
  ds_read_b64_tr_b16 v[180:181], v5 offset:40960
  ds_read_b64_tr_b16 v[182:183], v5 offset:41984
  s_waitcnt lgkmcnt(8)
  v_mfma_f32_32x32x16_bf16 v[16:31], v[184:187], v[104:107], v[16:31]
  v_mfma_f32_32x32x16_bf16 v[32:47], v[188:191], v[104:107], v[32:47]
  buffer_load_dwordx4 v[104:107], v1, s[8:11], s61 offen offset:2048 sc1
  s_waitcnt vmcnt(11)
  ds_read_b64_tr_b16 v[184:185], v4 offset:43008
  ds_read_b64_tr_b16 v[186:187], v4 offset:44032
  ds_read_b64_tr_b16 v[188:189], v5 offset:43008
  ds_read_b64_tr_b16 v[190:191], v5 offset:44032
  s_waitcnt lgkmcnt(8)
  v_mfma_f32_32x32x16_bf16 v[16:31], v[192:195], v[108:111], v[16:31]
  v_mfma_f32_32x32x16_bf16 v[32:47], v[196:199], v[108:111], v[32:47]
  buffer_load_dwordx4 v[108:111], v1, s[8:11], s61 offen offset:3072 sc1
  s_waitcnt vmcnt(11)
  ds_read_b64_tr_b16 v[192:193], v4 offset:45056
  ds_read_b64_tr_b16 v[194:195], v4 offset:46080
  ds_read_b64_tr_b16 v[196:197], v5 offset:45056
  ds_read_b64_tr_b16 v[198:199], v5 offset:46080
  s_waitcnt lgkmcnt(8)
  v_mfma_f32_32x32x16_bf16 v[16:31], v[176:179], v[64:67], v[16:31]
  v_mfma_f32_32x32x16_bf16 v[32:47], v[180:183], v[64:67], v[32:47]
  s_add_u32 s61, s61, 4096
  buffer_load_dwordx4 v[64:67], v1, s[8:11], s61 offen offset:0 sc1
  s_waitcnt vmcnt(11)
  ds_read_b64_tr_b16 v[176:177], v4 offset:47104
  ds_read_b64_tr_b16 v[178:179], v4 offset:48128
  ds_read_b64_tr_b16 v[180:181], v5 offset:47104
  ds_read_b64_tr_b16 v[182:183], v5 offset:48128
  s_waitcnt lgkmcnt(8)
  v_mfma_f32_32x32x16_bf16 v[16:31], v[184:187], v[68:71], v[16:31]
  v_mfma_f32_32x32x16_bf16 v[32:47], v[188:191], v[68:71], v[32:47]
  buffer_load_dwordx4 v[68:71], v1, s[8:11], s61 offen offset:1024 sc1
  s_waitcnt vmcnt(11)
  s_barrier
  ds_read_b64_tr_b16 v[184:185], v8 offset:0
  ds_read_b64_tr_b16 v[186:187], v8 offset:1024
  ds_read_b64_tr_b16 v[188:189], v9 offset:0
  ds_read_b64_tr_b16 v[190:191], v9 offset:1024
  s_waitcnt lgkmcnt(8)
  v_mfma_f32_32x32x16_bf16 v[16:31], v[192:195], v[72:75], v[16:31]
  v_mfma_f32_32x32x16_bf16 v[32:47], v[196:199], v[72:75], v[32:47]
  buffer_load_dwordx4 v[72:75], v1, s[8:11], s61 offen offset:2048 sc1
  s_waitcnt vmcnt(11)
  ds_read_b64_tr_b16 v[192:193], v8 offset:2048
  ds_read_b64_tr_b16 v[194:195], v8 offset:3072
  ds_read_b64_tr_b16 v[196:197], v9 offset:2048
  ds_read_b64_tr_b16 v[198:199], v9 offset:3072
  s_waitcnt lgkmcnt(8)
  v_mfma_f32_32x32x16_bf16 v[16:31], v[176:179], v[76:79], v[16:31]
  v_mfma_f32_32x32x16_bf16 v[32:47], v[180:183], v[76:79], v[32:47]
  buffer_load_dwordx4 v[76:79], v1, s[8:11], s61 offen offset:3072 sc1
  s_waitcnt vmcnt(11)
  ds_read_b64_tr_b16 v[176:177], v8 offset:4096
  ds_read_b64_tr_b16 v[178:179], v8 offset:5120
  ds_read_b64_tr_b16 v[180:181], v9 offset:4096
  ds_read_b64_tr_b16 v[182:183], v9 offset:5120
  s_waitcnt lgkmcnt(8)
  v_mfma_f32_32x32x16_bf16 v[16:31], v[184:187], v[80:83], v[16:31]
  v_mfma_f32_32x32x16_bf16 v[32:47], v[188:191], v[80:83], v[32:47]
  s_add_u32 s61, s61, 4096
  buffer_load_dwordx4 v[80:83], v1, s[8:11], s61 offen offset:0 sc1
  s_waitcnt vmcnt(11)
  ds_read_b64_tr_b16 v[184:185], v8 offset:6144
  ds_read_b64_tr_b16 v[186:187], v8 offset:7168
  ds_read_b64_tr_b16 v[188:189], v9 offset:6144
  ds_read_b64_tr_b16 v[190:191], v9 offset:7168
  s_waitcnt lgkmcnt(8)
  v_mfma_f32_32x32x16_bf16 v[16:31], v[192:195], v[84:87], v[16:31]
  v_mfma_f32_32x32x16_bf16 v[32:47], v[196:199], v[84:87], v[32:47]
  buffer_load_dwordx4 v[84:87], v1, s[8:11], s61 offen offset:1024 sc1
  s_waitcnt vmcnt(11)
  ds_read_b64_tr_b16 v[192:193], v8 offset:8192
  ds_read_b64_tr_b16 v[194:195], v8 offset:9216
  ds_read_b64_tr_b16 v[196:197], v9 offset:8192
  ds_read_b64_tr_b16 v[198:199], v9 offset:9216
  s_waitcnt lgkmcnt(8)
  v_mfma_f32_32x32x16_bf16 v[16:31], v[176:179], v[88:91], v[16:31]
  v_mfma_f32_32x32x16_bf16 v[32:47], v[180:183], v[88:91], v[32:47]
  buffer_load_dwordx4 v[88:91], v1, s[8:11], s61 offen offset:2048 sc1
  s_waitcnt vmcnt(11)
  ds_read_b64_tr_b16 v[176:177], v8 offset:10240
  ds_read_b64_tr_b16 v[178:179], v8 offset:11264
  ds_read_b64_tr_b16 v[180:181], v9 offset:10240
  ds_read_b64_tr_b16 v[182:183], v9 offset:11264
  s_waitcnt lgkmcnt(8)
  v_mfma_f32_32x32x16_bf16 v[16:31], v[184:187], v[92:95], v[16:31]
  v_mfma_f32_32x32x16_bf16 v[32:47], v[188:191], v[92:95], v[32:47]
  buffer_load_dwordx4 v[92:95], v1, s[8:11], s61 offen offset:3072 sc1
  s_waitcnt vmcnt(11)
  ds_read_b64_tr_b16 v[184:185], v8 offset:12288
  ds_read_b64_tr_b16 v[186:187], v8 offset:13312
  ds_read_b64_tr_b16 v[188:189], v9 offset:12288
  ds_read_b64_tr_b16 v[190:191], v9 offset:13312
  s_waitcnt lgkmcnt(8)
  v_mfma_f32_32x32x16_bf16 v[16:31], v[192:195], v[96:99], v[16:31]
  v_mfma_f32_32x32x16_bf16 v[32:47], v[196:199], v[96:99], v[32:47]
  s_add_u32 s61, s61, 4096
  buffer_load_dwordx4 v[96:99], v1, s[8:11], s61 offen offset:0 sc1
  s_waitcnt vmcnt(11)
  ds_read_b64_tr_b16 v[192:193], v8 offset:14336
  ds_read_b64_tr_b16 v[194:195], v8 offset:15360
  ds_read_b64_tr_b16 v[196:197], v9 offset:14336
  ds_read_b64_tr_b16 v[198:199], v9 offset:15360
  s_waitcnt lgkmcnt(8)
  v_mfma_f32_32x32x16_bf16 v[16:31], v[176:179], v[100:103], v[16:31]
  v_mfma_f32_32x32x16_bf16 v[32:47], v[180:183], v[100:103], v[32:47]
  buffer_load_dwordx4 v[100:103], v1, s[8:11], s61 offen offset:1024 sc1
  s_waitcnt vmcnt(11)
  s_barrier
  ds_read_b64_tr_b16 v[176:177], v8 offset:32768
  ds_read_b64_tr_b16 v[178:179], v8 offset:33792
  ds_read_b64_tr_b16 v[180:181], v9 offset:32768
  ds_read_b64_tr_b16 v[182:183], v9 offset:33792
  s_waitcnt lgkmcnt(8)
  v_mfma_f32_32x32x16_bf16 v[16:31], v[184:187], v[104:107], v[16:31]
  v_mfma_f32_32x32x16_bf16 v[32:47], v[188:191], v[104:107], v[32:47]
  buffer_load_dwordx4 v[104:107], v1, s[8:11], s61 offen offset:2048 sc1
  s_waitcnt vmcnt(11)
  ds_read_b64_tr_b16 v[184:185], v8 offset:34816
  ds_read_b64_tr_b16 v[186:187], v8 offset:35840
  ds_read_b64_tr_b16 v[188:189], v9 offset:34816
  ds_read_b64_tr_b16 v[190:191], v9 offset:35840
  s_waitcnt lgkmcnt(8)
  v_mfma_f32_32x32x16_bf16 v[16:31], v[192:195], v[108:111], v[16:31]
  v_mfma_f32_32x32x16_bf16 v[32:47], v[196:199], v[108:111], v[32:47]
  buffer_load_dwordx4 v[108:111], v1, s[8:11], s61 offen offset:3072 sc1
  s_waitcnt vmcnt(11)
  ds_read_b64_tr_b16 v[192:193], v8 offset:36864
  ds_read_b64_tr_b16 v[194:195], v8 offset:37888
  ds_read_b64_tr_b16 v[196:197], v9 offset:36864
  ds_read_b64_tr_b16 v[198:199], v9 offset:37888
  s_waitcnt lgkmcnt(8)
  v_mfma_f32_32x32x16_bf16 v[16:31], v[176:179], v[64:67], v[16:31]
  v_mfma_f32_32x32x16_bf16 v[32:47], v[180:183], v[64:67], v[32:47]
  s_add_u32 s61, s61, 4096
  buffer_load_dwordx4 v[64:67], v1, s[8:11], s61 offen offset:0 sc1
  s_waitcnt vmcnt(11)
  ds_read_b64_tr_b16 v[176:177], v8 offset:38912
  ds_read_b64_tr_b16 v[178:179], v8 offset:39936
  ds_read_b64_tr_b16 v[180:181], v9 offset:38912
  ds_read_b64_tr_b16 v[182:183], v9 offset:39936
  s_waitcnt lgkmcnt(8)
  v_mfma_f32_32x32x16_bf16 v[16:31], v[184:187], v[68:71], v[16:31]
  v_mfma_f32_32x32x16_bf16 v[32:47], v[188:191], v[68:71], v[32:47]
  buffer_load_dwordx4 v[68:71], v1, s[8:11], s61 offen offset:1024 sc1
  s_waitcnt vmcnt(11)
  ds_read_b64_tr_b16 v[184:185], v8 offset:40960
  ds_read_b64_tr_b16 v[186:187], v8 offset:41984
  ds_read_b64_tr_b16 v[188:189], v9 offset:40960
  ds_read_b64_tr_b16 v[190:191], v9 offset:41984
  s_waitcnt lgkmcnt(8)
  v_mfma_f32_32x32x16_bf16 v[16:31], v[192:195], v[72:75], v[16:31]
  v_mfma_f32_32x32x16_bf16 v[32:47], v[196:199], v[72:75], v[32:47]
  buffer_load_dwordx4 v[72:75], v1, s[8:11], s61 offen offset:2048 sc1
  s_waitcnt vmcnt(11)
  ds_read_b64_tr_b16 v[192:193], v8 offset:43008
  ds_read_b64_tr_b16 v[194:195], v8 offset:44032
  ds_read_b64_tr_b16 v[196:197], v9 offset:43008
  ds_read_b64_tr_b16 v[198:199], v9 offset:44032
  s_waitcnt lgkmcnt(8)
  v_mfma_f32_32x32x16_bf16 v[16:31], v[176:179], v[76:79], v[16:31]
  v_mfma_f32_32x32x16_bf16 v[32:47], v[180:183], v[76:79], v[32:47]
  buffer_load_dwordx4 v[76:79], v1, s[8:11], s61 offen offset:3072 sc1
  s_waitcnt vmcnt(11)
  ds_read_b64_tr_b16 v[176:177], v8 offset:45056
  ds_read_b64_tr_b16 v[178:179], v8 offset:46080
  ds_read_b64_tr_b16 v[180:181], v9 offset:45056
  ds_read_b64_tr_b16 v[182:183], v9 offset:46080
  s_waitcnt lgkmcnt(8)
  v_mfma_f32_32x32x16_bf16 v[16:31], v[184:187], v[80:83], v[16:31]
  v_mfma_f32_32x32x16_bf16 v[32:47], v[188:191], v[80:83], v[32:47]
  s_add_u32 s61, s61, 4096
  buffer_load_dwordx4 v[80:83], v1, s[8:11], s61 offen offset:0 sc1
  s_waitcnt vmcnt(11)
  ds_read_b64_tr_b16 v[184:185], v8 offset:47104
  ds_read_b64_tr_b16 v[186:187], v8 offset:48128
  ds_read_b64_tr_b16 v[188:189], v9 offset:47104
  ds_read_b64_tr_b16 v[190:191], v9 offset:48128
  s_waitcnt lgkmcnt(8)
  v_mfma_f32_32x32x16_bf16 v[16:31], v[192:195], v[84:87], v[16:31]
  v_mfma_f32_32x32x16_bf16 v[32:47], v[196:199], v[84:87], v[32:47]
  buffer_load_dwordx4 v[84:87], v1, s[8:11], s61 offen offset:1024 sc1
  s_waitcnt vmcnt(11)
  s_barrier
  ds_read_b64_tr_b16 v[192:193], v4 offset:0
  ds_read_b64_tr_b16 v[194:195], v4 offset:1024
  ds_read_b64_tr_b16 v[196:197], v5 offset:0
  ds_read_b64_tr_b16 v[198:199], v5 offset:1024
  s_waitcnt lgkmcnt(8)
  v_mfma_f32_32x32x16_bf16 v[16:31], v[176:179], v[88:91], v[16:31]
  v_mfma_f32_32x32x16_bf16 v[32:47], v[180:183], v[88:91], v[32:47]
  buffer_load_dwordx4 v[88:91], v1, s[8:11], s61 offen offset:2048 sc1
  s_waitcnt vmcnt(11)
  ds_read_b64_tr_b16 v[176:177], v4 offset:2048
  ds_read_b64_tr_b16 v[178:179], v4 offset:3072
  ds_read_b64_tr_b16 v[180:181], v5 offset:2048
  ds_read_b64_tr_b16 v[182:183], v5 offset:3072
  s_waitcnt lgkmcnt(8)
  v_mfma_f32_32x32x16_bf16 v[16:31], v[184:187], v[92:95], v[16:31]
  v_mfma_f32_32x32x16_bf16 v[32:47], v[188:191], v[92:95], v[32:47]
  buffer_load_dwordx4 v[92:95], v1, s[8:11], s61 offen offset:3072 sc1
  s_waitcnt vmcnt(11)
  ds_read_b64_tr_b16 v[184:185], v4 offset:4096
  ds_read_b64_tr_b16 v[186:187], v4 offset:5120
  ds_read_b64_tr_b16 v[188:189], v5 offset:4096
  ds_read_b64_tr_b16 v[190:191], v5 offset:5120
  s_waitcnt lgkmcnt(8)
  v_mfma_f32_32x32x16_bf16 v[16:31], v[192:195], v[96:99], v[16:31]
  v_mfma_f32_32x32x16_bf16 v[32:47], v[196:199], v[96:99], v[32:47]
  s_add_u32 s61, s61, 4096
  buffer_load_dwordx4 v[96:99], v1, s[8:11], s61 offen offset:0 sc1
  s_waitcnt vmcnt(11)
  ds_read_b64_tr_b16 v[192:193], v4 offset:6144
  ds_read_b64_tr_b16 v[194:195], v4 offset:7168
  ds_read_b64_tr_b16 v[196:197], v5 offset:6144
  ds_read_b64_tr_b16 v[198:199], v5 offset:7168
  s_waitcnt lgkmcnt(8)
  v_mfma_f32_32x32x16_bf16 v[16:31], v[176:179], v[100:103], v[16:31]
  v_mfma_f32_32x32x16_bf16 v[32:47], v[180:183], v[100:103], v[32:47]
  buffer_load_dwordx4 v[100:103], v1, s[8:11], s61 offen offset:1024 sc1
  s_waitcnt vmcnt(11)
  ds_read_b64_tr_b16 v[176:177], v4 offset:8192
  ds_read_b64_tr_b16 v[178:179], v4 offset:9216
  ds_read_b64_tr_b16 v[180:181], v5 offset:8192
  ds_read_b64_tr_b16 v[182:183], v5 offset:9216
  s_waitcnt lgkmcnt(8)
  v_mfma_f32_32x32x16_bf16 v[16:31], v[184:187], v[104:107], v[16:31]
  v_mfma_f32_32x32x16_bf16 v[32:47], v[188:191], v[104:107], v[32:47]
  buffer_load_dwordx4 v[104:107], v1, s[8:11], s61 offen offset:2048 sc1
  s_waitcnt vmcnt(11)
  ds_read_b64_tr_b16 v[184:185], v4 offset:10240
  ds_read_b64_tr_b16 v[186:187], v4 offset:11264
  ds_read_b64_tr_b16 v[188:189], v5 offset:10240
  ds_read_b64_tr_b16 v[190:191], v5 offset:11264
  s_waitcnt lgkmcnt(8)
  v_mfma_f32_32x32x16_bf16 v[16:31], v[192:195], v[108:111], v[16:31]
  v_mfma_f32_32x32x16_bf16 v[32:47], v[196:199], v[108:111], v[32:47]
  buffer_load_dwordx4 v[108:111], v1, s[8:11], s61 offen offset:3072 sc1
  s_waitcnt vmcnt(11)
  ds_read_b64_tr_b16 v[192:193], v4 offset:12288
  ds_read_b64_tr_b16 v[194:195], v4 offset:13312
  ds_read_b64_tr_b16 v[196:197], v5 offset:12288
  ds_read_b64_tr_b16 v[198:199], v5 offset:13312
  s_waitcnt lgkmcnt(8)
  v_mfma_f32_32x32x16_bf16 v[16:31], v[176:179], v[64:67], v[16:31]
  v_mfma_f32_32x32x16_bf16 v[32:47], v[180:183], v[64:67], v[32:47]
  s_add_u32 s61, s61, 4096
  buffer_load_dwordx4 v[64:67], v1, s[8:11], s61 offen offset:0 sc1
  s_waitcnt vmcnt(11)
  ds_read_b64_tr_b16 v[176:177], v4 offset:14336
  ds_read_b64_tr_b16 v[178:179], v4 offset:15360
  ds_read_b64_tr_b16 v[180:181], v5 offset:14336
  ds_read_b64_tr_b16 v[182:183], v5 offset:15360
  s_waitcnt lgkmcnt(8)
  v_mfma_f32_32x32x16_bf16 v[16:31], v[184:187], v[68:71], v[16:31]
  v_mfma_f32_32x32x16_bf16 v[32:47], v[188:191], v[68:71], v[32:47]
  buffer_load_dwordx4 v[68:71], v1, s[8:11], s61 offen offset:1024 sc1
  s_waitcnt vmcnt(11)
  s_barrier
  ds_read_b64_tr_b16 v[184:185], v4 offset:32768
  ds_read_b64_tr_b16 v[186:187], v4 offset:33792
  ds_read_b64_tr_b16 v[188:189], v5 offset:32768
  ds_read_b64_tr_b16 v[190:191], v5 offset:33792
  s_waitcnt lgkmcnt(8)
  v_mfma_f32_32x32x16_bf16 v[16:31], v[192:195], v[72:75], v[16:31]
  v_mfma_f32_32x32x16_bf16 v[32:47], v[196:199], v[72:75], v[32:47]
  buffer_load_dwordx4 v[72:75], v1, s[8:11], s61 offen offset:2048 sc1
  s_waitcnt vmcnt(11)
  ds_read_b64_tr_b16 v[192:193], v4 offset:34816
  ds_read_b64_tr_b16 v[194:195], v4 offset:35840
  ds_read_b64_tr_b16 v[196:197], v5 offset:34816
  ds_read_b64_tr_b16 v[198:199], v5 offset:35840
  s_waitcnt lgkmcnt(8)
  v_mfma_f32_32x32x16_bf16 v[16:31], v[176:179], v[76:79], v[16:31]
  v_mfma_f32_32x32x16_bf16 v[32:47], v[180:183], v[76:79], v[32:47]
  buffer_load_dwordx4 v[76:79], v1, s[8:11], s61 offen offset:3072 sc1
  s_waitcnt vmcnt(11)
  ds_read_b64_tr_b16 v[176:177], v4 offset:36864
  ds_read_b64_tr_b16 v[178:179], v4 offset:37888
  ds_read_b64_tr_b16 v[180:181], v5 offset:36864
  ds_read_b64_tr_b16 v[182:183], v5 offset:37888
  s_waitcnt lgkmcnt(8)
  v_mfma_f32_32x32x16_bf16 v[16:31], v[184:187], v[80:83], v[16:31]
  v_mfma_f32_32x32x16_bf16 v[32:47], v[188:191], v[80:83], v[32:47]
  s_add_u32 s61, s61, 4096
  buffer_load_dwordx4 v[80:83], v1, s[8:11], s61 offen offset:0 sc1
  s_waitcnt vmcnt(11)
  ds_read_b64_tr_b16 v[184:185], v4 offset:38912
  ds_read_b64_tr_b16 v[186:187], v4 offset:39936
  ds_read_b64_tr_b16 v[188:189], v5 offset:38912
  ds_read_b64_tr_b16 v[190:191], v5 offset:39936
  s_waitcnt lgkmcnt(8)
  v_mfma_f32_32x32x16_bf16 v[16:31], v[192:195], v[84:87], v[16:31]
  v_mfma_f32_32x32x16_bf16 v[32:47], v[196:199], v[84:87], v[32:47]
  buffer_load_dwordx4 v[84:87], v1, s[8:11], s61 offen offset:1024 sc1
  s_waitcnt vmcnt(11)
  ds_read_b64_tr_b16 v[192:193], v4 offset:40960
  ds_read_b64_tr_b16 v[194:195], v4 offset:41984
  ds_read_b64_tr_b16 v[196:197], v5 offset:40960
  ds_read_b64_tr_b16 v[198:199], v5 offset:41984
  s_waitcnt lgkmcnt(8)
  v_mfma_f32_32x32x16_bf16 v[16:31], v[176:179], v[88:91], v[16:31]
  v_mfma_f32_32x32x16_bf16 v[32:47], v[180:183], v[88:91], v[32:47]
  buffer_load_dwordx4 v[88:91], v1, s[8:11], s61 offen offset:2048 sc1
  s_waitcnt vmcnt(11)
  ds_read_b64_tr_b16 v[176:177], v4 offset:43008
  ds_read_b64_tr_b16 v[178:179], v4 offset:44032
  ds_read_b64_tr_b16 v[180:181], v5 offset:43008
  ds_read_b64_tr_b16 v[182:183], v5 offset:44032
  s_waitcnt lgkmcnt(8)
  v_mfma_f32_32x32x16_bf16 v[16:31], v[184:187], v[92:95], v[16:31]
  v_mfma_f32_32x32x16_bf16 v[32:47], v[188:191], v[92:95], v[32:47]
  buffer_load_dwordx4 v[92:95], v1, s[8:11], s61 offen offset:3072 sc1
  s_waitcnt vmcnt(11)
  ds_read_b64_tr_b16 v[184:185], v4 offset:45056
  ds_read_b64_tr_b16 v[186:187], v4 offset:46080
  ds_read_b64_tr_b16 v[188:189], v5 offset:45056
  ds_read_b64_tr_b16 v[190:191], v5 offset:46080
  s_waitcnt lgkmcnt(8)
  v_mfma_f32_32x32x16_bf16 v[16:31], v[192:195], v[96:99], v[16:31]
  v_mfma_f32_32x32x16_bf16 v[32:47], v[196:199], v[96:99], v[32:47]
  s_waitcnt vmcnt(10)
  ds_read_b64_tr_b16 v[192:193], v4 offset:47104
  ds_read_b64_tr_b16 v[194:195], v4 offset:48128
  ds_read_b64_tr_b16 v[196:197], v5 offset:47104
  ds_read_b64_tr_b16 v[198:199], v5 offset:48128
  s_waitcnt lgkmcnt(8)
  v_mfma_f32_32x32x16_bf16 v[16:31], v[176:179], v[100:103], v[16:31]
  v_mfma_f32_32x32x16_bf16 v[32:47], v[180:183], v[100:103], v[32:47]
  s_waitcnt vmcnt(9)
  s_barrier
  ds_read_b64_tr_b16 v[176:177], v8 offset:0
  ds_read_b64_tr_b16 v[178:179], v8 offset:1024
  ds_read_b64_tr_b16 v[180:181], v9 offset:0
  ds_read_b64_tr_b16 v[182:183], v9 offset:1024
  s_waitcnt lgkmcnt(8)
  v_mfma_f32_32x32x16_bf16 v[16:31], v[184:187], v[104:107], v[16:31]
  v_mfma_f32_32x32x16_bf16 v[32:47], v[188:191], v[104:107], v[32:47]
  s_waitcnt vmcnt(8)
  ds_read_b64_tr_b16 v[184:185], v8 offset:2048
  ds_read_b64_tr_b16 v[186:187], v8 offset:3072
  ds_read_b64_tr_b16 v[188:189], v9 offset:2048
  ds_read_b64_tr_b16 v[190:191], v9 offset:3072
  s_waitcnt lgkmcnt(8)
  v_mfma_f32_32x32x16_bf16 v[16:31], v[192:195], v[108:111], v[16:31]
  v_mfma_f32_32x32x16_bf16 v[32:47], v[196:199], v[108:111], v[32:47]
  s_waitcnt vmcnt(7)
  ds_read_b64_tr_b16 v[192:193], v8 offset:4096
  ds_read_b64_tr_b16 v[194:195], v8 offset:5120
  ds_read_b64_tr_b16 v[196:197], v9 offset:4096
  ds_read_b64_tr_b16 v[198:199], v9 offset:5120
  s_waitcnt lgkmcnt(8)
  v_mfma_f32_32x32x16_bf16 v[16:31], v[176:179], v[64:67], v[16:31]
  v_mfma_f32_32x32x16_bf16 v[32:47], v[180:183], v[64:67], v[32:47]
  s_waitcnt vmcnt(6)
  ds_read_b64_tr_b16 v[176:177], v8 offset:6144
  ds_read_b64_tr_b16 v[178:179], v8 offset:7168
  ds_read_b64_tr_b16 v[180:181], v9 offset:6144
  ds_read_b64_tr_b16 v[182:183], v9 offset:7168
  s_waitcnt lgkmcnt(8)
  v_mfma_f32_32x32x16_bf16 v[16:31], v[184:187], v[68:71], v[16:31]
  v_mfma_f32_32x32x16_bf16 v[32:47], v[188:191], v[68:71], v[32:47]
  s_waitcnt vmcnt(5)
  ds_read_b64_tr_b16 v[184:185], v8 offset:8192
  ds_read_b64_tr_b16 v[186:187], v8 offset:9216
  ds_read_b64_tr_b16 v[188:189], v9 offset:8192
  ds_read_b64_tr_b16 v[190:191], v9 offset:9216
  s_waitcnt lgkmcnt(8)
  v_mfma_f32_32x32x16_bf16 v[16:31], v[192:195], v[72:75], v[16:31]
  v_mfma_f32_32x32x16_bf16 v[32:47], v[196:199], v[72:75], v[32:47]
  s_waitcnt vmcnt(4)
  ds_read_b64_tr_b16 v[192:193], v8 offset:10240
  ds_read_b64_tr_b16 v[194:195], v8 offset:11264
  ds_read_b64_tr_b16 v[196:197], v9 offset:10240
  ds_read_b64_tr_b16 v[198:199], v9 offset:11264
  s_waitcnt lgkmcnt(8)
  v_mfma_f32_32x32x16_bf16 v[16:31], v[176:179], v[76:79], v[16:31]
  v_mfma_f32_32x32x16_bf16 v[32:47], v[180:183], v[76:79], v[32:47]
  s_waitcnt vmcnt(3)
  ds_read_b64_tr_b16 v[176:177], v8 offset:12288
  ds_read_b64_tr_b16 v[178:179], v8 offset:13312
  ds_read_b64_tr_b16 v[180:181], v9 offset:12288
  ds_read_b64_tr_b16 v[182:183], v9 offset:13312
  s_waitcnt lgkmcnt(8)
  v_mfma_f32_32x32x16_bf16 v[16:31], v[184:187], v[80:83], v[16:31]
  v_mfma_f32_32x32x16_bf16 v[32:47], v[188:191], v[80:83], v[32:47]
  s_waitcnt vmcnt(2)
  ds_read_b64_tr_b16 v[184:185], v8 offset:14336
  ds_read_b64_tr_b16 v[186:187], v8 offset:15360
  ds_read_b64_tr_b16 v[188:189], v9 offset:14336
  ds_read_b64_tr_b16 v[190:191], v9 offset:15360
  s_waitcnt lgkmcnt(8)
  v_mfma_f32_32x32x16_bf16 v[16:31], v[192:195], v[84:87], v[16:31]
  v_mfma_f32_32x32x16_bf16 v[32:47], v[196:199], v[84:87], v[32:47]
  s_waitcnt vmcnt(1)
  s_waitcnt lgkmcnt(4)
  v_mfma_f32_32x32x16_bf16 v[16:31], v[176:179], v[88:91], v[16:31]
  v_mfma_f32_32x32x16_bf16 v[32:47], v[180:183], v[88:91], v[32:47]
  s_waitcnt vmcnt(0)
  s_waitcnt lgkmcnt(0)
  v_mfma_f32_32x32x16_bf16 v[16:31], v[184:187], v[92:95], v[16:31]
  v_mfma_f32_32x32x16_bf16 v[32:47], v[188:191], v[92:95], v[32:47]
  s_nop 11
  s_lshl_b32 s52, s46, 12
  s_add_u32 s52, s52, 131072
  v_add_u32 v6, s52, v1
  ds_write_b128 v6, v[32:35] offset:0
  ds_write_b128 v6, v[36:39] offset:1024
  ds_write_b128 v6, v[40:43] offset:2048
  ds_write_b128 v6, v[44:47] offset:3072
  s_lshl_b32 s56, s44, 2
  s_lshr_b32 s53, s45, 3
  s_lshl_b32 s53, s53, 1
  s_add_u32 s56, s56, s53
  s_and_b32 s53, s46, 1
  s_add_u32 s56, s56, s53
  s_lshr_b32 s55, s46, 1
  s_lshl_b32 s52, s56, 15
  s_and_b32 s53, s45, 7
  s_lshl_b32 s54, s53, 12
  s_add_u32 s52, s52, s54
  s_lshl_b32 s54, s55, 11
  s_add_u32 s52, s52, s54
  s_add_u32 s52, s52, 1048576
  s_lshl_b32 s57, s56, 12
  s_lshl_b32 s54, s53, 9
  s_add_u32 s57, s57, s54
  s_lshl_b32 s54, s55, 8
  s_add_u32 s57, s57, s54
  s_add_u32 s57, s57, 7340032
  s_xor_b32 s58, s46, 2
  s_lshl_b32 s58, s58, 12
  s_add_u32 s58, s58, 131072
  v_add_u32 v7, s58, v1
  v_and_b32 v10, 31, v0
  v_lshlrev_b32 v10, 3, v10
  s_waitcnt lgkmcnt(0)
  s_barrier
  ds_read_b128 v[32:35], v7 offset:0
  ds_read_b128 v[36:39], v7 offset:1024
  ds_read_b128 v[40:43], v7 offset:2048
  ds_read_b128 v[44:47], v7 offset:3072
  s_waitcnt lgkmcnt(3)
  v_pk_add_f32 v[16:17], v[16:17], v[32:33]
  v_pk_add_f32 v[18:19], v[18:19], v[34:35]
  s_waitcnt lgkmcnt(2)
  v_pk_add_f32 v[20:21], v[20:21], v[36:37]
  v_pk_add_f32 v[22:23], v[22:23], v[38:39]
  s_waitcnt lgkmcnt(1)
  v_pk_add_f32 v[24:25], v[24:25], v[40:41]
  v_pk_add_f32 v[26:27], v[26:27], v[42:43]
  s_waitcnt lgkmcnt(0)
  v_pk_add_f32 v[28:29], v[28:29], v[44:45]
  v_pk_add_f32 v[30:31], v[30:31], v[46:47]
  v_cvt_pk_bf16_f32 v248, v16, v17
  v_cvt_pk_bf16_f32 v249, v18, v19
  v_cvt_pk_bf16_f32 v250, v20, v21
  v_cvt_pk_bf16_f32 v251, v22, v23
  v_cvt_pk_bf16_f32 v252, v24, v25
  v_cvt_pk_bf16_f32 v253, v26, v27
  v_cvt_pk_bf16_f32 v254, v28, v29
  v_cvt_pk_bf16_f32 v255, v30, v31
  s_cmp_eq_u32 s48, 1
  s_cbranch_scc1 L_final_131
  s_cmp_eq_u32 s47, 1
  s_cbranch_scc1 L_fast_133
  buffer_store_dwordx4 v[248:251], v1, s[8:11], s52 offen sc1
  buffer_store_dwordx4 v[252:255], v1, s[8:11], s52 offen offset:1024 sc1
  s_branch L_join_134
L_fast_133:
  buffer_store_dwordx4 v[248:251], v1, s[8:11], s52 offen
  buffer_store_dwordx4 v[252:255], v1, s[8:11], s52 offen offset:1024
L_join_134:
  v_pk_mul_f32 v[32:33], v[16:17], v[16:17]
  v_pk_add_f32 v[34:35], v[16:17], v[18:19]
  v_pk_fma_f32 v[32:33], v[18:19], v[18:19], v[32:33]
  v_pk_add_f32 v[34:35], v[34:35], v[20:21]
  v_pk_fma_f32 v[32:33], v[20:21], v[20:21], v[32:33]
  v_pk_add_f32 v[34:35], v[34:35], v[22:23]
  v_pk_fma_f32 v[32:33], v[22:23], v[22:23], v[32:33]
  v_pk_add_f32 v[34:35], v[34:35], v[24:25]
  v_pk_fma_f32 v[32:33], v[24:25], v[24:25], v[32:33]
  v_pk_add_f32 v[34:35], v[34:35], v[26:27]
  v_pk_fma_f32 v[32:33], v[26:27], v[26:27], v[32:33]
  v_pk_add_f32 v[34:35], v[34:35], v[28:29]
  v_pk_fma_f32 v[32:33], v[28:29], v[28:29], v[32:33]
  v_pk_add_f32 v[34:35], v[34:35], v[30:31]
  v_pk_fma_f32 v[32:33], v[30:31], v[30:31], v[32:33]
  v_add_f32 v8, v34, v35
  v_add_f32 v9, v32, v33
  v_mov_b32 v12, v8
  v_mov_b32 v13, v9
  s_nop 1
  v_permlane32_swap_b32 v12, v8
  v_permlane32_swap_b32 v13, v9
  s_nop 0
  v_pk_add_f32 v[8:9], v[8:9], v[12:13]
  s_cmp_eq_u32 s47, 1
  s_cbranch_scc1 L_fast_135
  s_mov_b64 exec, s[88:89]
  buffer_store_dwordx2 v[8:9], v10, s[8:11], s57 offen sc1
  s_mov_b64 exec, -1
  s_branch L_join_136
L_fast_135:
  s_mov_b64 exec, s[88:89]
  buffer_store_dwordx2 v[8:9], v10, s[8:11], s57 offen
  s_mov_b64 exec, -1
L_join_136:
  s_waitcnt vmcnt(0)
  s_lshl_b32 s52, s48, 2
  s_add_u32 s52, s52, 4
  v_mov_b32 v4, s52
  v_mov_b32 v5, 0
  s_mov_b64 exec, 1
  s_cmp_eq_u32 s47, 1
  s_cbranch_scc1 L_fast_137
  buffer_store_dword v4, v5, s[8:11], s50 offen sc1
  s_branch L_join_138
L_fast_137:
  buffer_store_dword v4, v5, s[8:11], s50 offen
L_join_138:
  s_mov_b64 exec, -1
  s_branch L_fj_132
L_final_131:
  v_and_b32 v10, 31, v0
  v_lshlrev_b32 v10, 10, v10
  v_lshrrev_b32 v11, 5, v0
  v_lshl_add_u32 v10, v11, 3, v10
  s_lshl_b32 s52, s56, 15
  s_lshl_b32 s54, s53, 7
  s_add_u32 s52, s52, s54
  s_lshl_b32 s54, s55, 6
  s_add_u32 s52, s52, s54
  buffer_store_dwordx2 v[248:249], v10, s[32:35], s52 offen offset:0
  buffer_store_dwordx2 v[250:251], v10, s[32:35], s52 offen offset:16
  buffer_store_dwordx2 v[252:253], v10, s[32:35], s52 offen offset:32
  buffer_store_dwordx2 v[254:255], v10, s[32:35], s52 offen offset:48
  s_branch L_end
L_fj_132:
  s_mov_b32 s48, 1
  s_mov_b32 s94, 2097152
  s_branch L_p1_l1
L_end:
  s_endpgm
.section .rodata,"a"
.p2align 6
.amdhsa_kernel interleave_layers__sliding_block__dense_activation_squared_relu__prompt_kernel
  .amdhsa_next_free_vgpr 256
  .amdhsa_next_free_sgpr 102
  .amdhsa_accum_offset 256
  .amdhsa_group_segment_fixed_size 0
  .amdhsa_kernarg_size 88
  .amdhsa_user_sgpr_count 2
  .amdhsa_user_sgpr_kernarg_segment_ptr 1
  .amdhsa_system_sgpr_workgroup_id_x 1
.end_amdhsa_kernel
```
